```python
import torch

def _softmax(x, axis=-1):
    return torch.softmax(x, dim=axis)
def _gelu(x):
    return torch.nn.functional.gelu(x, approximate="tanh")
def _silu(x):
    return torch.nn.functional.silu(x)
def _sigmoid(x):
    return torch.sigmoid(x)
def _layernorm(x, axis=-1, eps=1e-5):
    m = x.mean(dim=axis, keepdim=True)
    v = x.var(dim=axis, keepdim=True, unbiased=False)
    return (x - m) / torch.sqrt(v + eps)
def _scatter_add(tgt, idx, src, axis=0):
    return tgt.clone().index_add_(axis, idx, src)
def _segment_sum(src, seg, n):
    out = torch.zeros((n,) + src.shape[1:], dtype=src.dtype)
    return out.index_add_(0, seg, src)
def _pad(x, pw):
    flat = tuple(v for pair in reversed(pw) for v in pair)
    return torch.nn.functional.pad(x, flat)

kernel_name = 'parallel_sum__gqa_block_cached__glu_gated_reglu__decode'

def setup_inputs():

    _w = (lambda a: (lambda t: t.to(torch.bfloat16) if t.is_floating_point() else t)(torch.as_tensor(a)))
    def _A_setup():
        B, Sq, D = 1, 1, 448
        Hq, Hkv, Sk, Dh = 16, 8, 65536, 256
        assert Hq % Hkv == 0, (Hq, Hkv)
        return {
            "x": _w((lambda *s: torch.randn(*s, dtype=torch.bfloat16) * 0.05)(B, Sq, D)),
            "k_cache": _w((lambda *s: torch.randn(*s, dtype=torch.bfloat16) * 3.2)(B, Hkv, Sk, Dh)),
            "v_cache": _w((lambda *s: torch.randn(*s, dtype=torch.bfloat16) * 1.6)(B, Hkv, Sk, Dh)),
            "wq": _w((lambda *s: torch.randn(*s, dtype=torch.bfloat16) * 3.2)(D, Hq * Dh) * (D ** -0.5)),
            "wo": _w((lambda *s: torch.randn(*s, dtype=torch.bfloat16) * 1.6)(Hq * Dh, D) * ((Hq * Dh) ** -0.5)),
        }
    _A_in = _A_setup()

    def _B_setup():
        B, S, D, F = 1, 1, 448, 1792
        return {
            "x": _w((lambda *s: torch.randn(*s, dtype=torch.bfloat16) * 0.05)(B, S, D)),
            "W_gate": _w((lambda *s: torch.randn(*s, dtype=torch.bfloat16) * 1.6)(D, F) * (2.0 / D) ** 0.5),
            "W_up": _w((lambda *s: torch.randn(*s, dtype=torch.bfloat16) * 1.6)(D, F) * (2.0 / D) ** 0.5),
            "W_down": _w((lambda *s: torch.randn(*s, dtype=torch.bfloat16) * 1.6)(F, D) * (1.0 / F) ** 0.5),
        }
    _B_in = _B_setup()

    return {
        "A_x": _A_in["x"],
        "A_k_cache": _A_in["k_cache"],
        "A_v_cache": _A_in["v_cache"],
        "A_wq": _A_in["wq"],
        "A_wo": _A_in["wo"],
        "B_x": _B_in["x"],
        "B_W_gate": _B_in["W_gate"],
        "B_W_up": _B_in["W_up"],
        "B_W_down": _B_in["W_down"],
    }

def reference(A_x, A_k_cache, A_v_cache, A_wq, A_wo, B_x, B_W_gate, B_W_up, B_W_down):
    def _A_ref(x, k_cache, v_cache, wq, wo):
        B, Sq, D = x.shape
        Hq, Dh = 16, 256
        Hkv = k_cache.shape[1]
        rep = Hq // Hkv
        q = (lambda x, *d: x.permute(*d))((x @ wq).reshape(B, Sq, Hq, Dh), 0, 2, 1, 3)
        k = (lambda x, n, axis: torch.repeat_interleave(x, n, dim=axis))(k_cache, rep, axis=1)
        v = (lambda x, n, axis: torch.repeat_interleave(x, n, dim=axis))(v_cache, rep, axis=1)
        scores = torch.einsum("bhqd,bhkd->bhqk", q, k) * (Dh ** -0.5)
        p = _softmax(scores, axis=-1)
        o = torch.einsum("bhqk,bhkd->bhqd", p, v)
        return (lambda x, *d: x.permute(*d))(o, 0, 2, 1, 3).reshape(B, Sq, Hq * Dh) @ wo

    def _B_ref(x, W_gate, W_up, W_down):
        gate = torch.einsum("bsd,df->bsf", x, W_gate)
        up = torch.einsum("bsd,df->bsf", x, W_up)
        gate = gate * (lambda x, dt: x.to(dt))(gate > 0, gate.dtype)
        h = gate * up
        return torch.einsum("bsf,fd->bsd", h, W_down)

    x = A_x
    xn = _layernorm(x, axis=-1)
    return x + _A_ref(xn, A_k_cache, A_v_cache, A_wq, A_wo) + _B_ref(xn, B_W_gate, B_W_up, B_W_down)
```

```asm
; @launch grid=(256,1,1) block=(256,1,1) lds=18432
.amdgcn_target "amdgcn-amd-amdhsa--gfx950"
.text
.globl parallel_sum__gqa_block_cached__glu_gated_reglu__decode_kernel
.p2align 8
.type parallel_sum__gqa_block_cached__glu_gated_reglu__decode_kernel,@function
parallel_sum__gqa_block_cached__glu_gated_reglu__decode_kernel:
  s_cmp_ge_u32 s2, 256
  s_cbranch_scc1 L_end
  s_load_dwordx16 s[4:19], s[0:1], 0
  s_load_dwordx8 s[20:27], s[0:1], 64
  v_and_b32 v1, 63, v0
  v_lshrrev_b32 v22, 6, v0
  s_bfe_u32 s44, s2, 0x30003
  s_lshr_b32 s45, s2, 6
  s_lshl_b32 s45, s45, 3
  s_and_b32 s95, s2, 7
  s_add_u32 s45, s45, s95
  v_readfirstlane_b32 s46, v22
  s_cmp_eq_u32 s46, 0
  s_cbranch_scc1 L_helper1
  v_and_b32 v23, 15, v1
  v_lshrrev_b32 v24, 4, v1
  v_lshlrev_b32 v2, 9, v23
  v_lshl_add_u32 v2, v24, 4, v2
  v_lshlrev_b32 v3, 11, v24
  v_lshl_add_u32 v3, v23, 4, v3
  s_lshl_b32 s49, s44, 25
  s_lshr_b32 s50, s2, 6
  s_lshl_b32 s50, s50, 23
  s_add_u32 s49, s49, s50
  s_mul_i32 s92, s95, 3
  s_add_u32 s92, s92, s46
  s_sub_u32 s92, s92, 1
  s_lshl_b32 s92, s92, 13
  s_mov_b32 s56, s92
  s_waitcnt lgkmcnt(0)
  s_load_dword s48, s[26:27], 0
  s_add_u32 s28, s6, s49
  s_addc_u32 s29, s7, 0
  s_mov_b32 s30, 8388608
  s_mov_b32 s31, 0x00020000
  s_add_u32 s32, s8, s49
  s_addc_u32 s33, s9, 0
  s_mov_b32 s34, 8388608
  s_mov_b32 s35, 0x00020000
  s_barrier
  buffer_load_dwordx4 a[0:3], v2, s[28:31], s56 offen offset:0 nt
  buffer_load_dwordx4 a[4:7], v2, s[28:31], s56 offen offset:64 nt
  buffer_load_dwordx4 a[8:11], v2, s[28:31], s56 offen offset:128 nt
  buffer_load_dwordx4 a[12:15], v2, s[28:31], s56 offen offset:192 nt
  buffer_load_dwordx4 a[16:19], v2, s[28:31], s56 offen offset:256 nt
  buffer_load_dwordx4 a[20:23], v2, s[28:31], s56 offen offset:320 nt
  buffer_load_dwordx4 a[24:27], v2, s[28:31], s56 offen offset:384 nt
  buffer_load_dwordx4 a[28:31], v2, s[28:31], s56 offen offset:448 nt
  buffer_load_dwordx4 a[32:35], v3, s[32:35], s56 offen offset:0 nt
  buffer_load_dwordx4 a[36:39], v3, s[32:35], s56 offen offset:256 nt
  buffer_load_dwordx4 a[40:43], v3, s[32:35], s56 offen offset:512 nt
  buffer_load_dwordx4 a[44:47], v3, s[32:35], s56 offen offset:768 nt
  buffer_load_dwordx4 a[48:51], v3, s[32:35], s56 offen offset:1024 nt
  buffer_load_dwordx4 a[52:55], v3, s[32:35], s56 offen offset:1280 nt
  buffer_load_dwordx4 a[56:59], v3, s[32:35], s56 offen offset:1536 nt
  buffer_load_dwordx4 a[60:63], v3, s[32:35], s56 offen offset:1792 nt
  s_add_u32 s56, s56, 196608
  buffer_load_dwordx4 a[64:67], v2, s[28:31], s56 offen offset:0 nt
  buffer_load_dwordx4 a[68:71], v2, s[28:31], s56 offen offset:64 nt
  buffer_load_dwordx4 a[72:75], v2, s[28:31], s56 offen offset:128 nt
  buffer_load_dwordx4 a[76:79], v2, s[28:31], s56 offen offset:192 nt
  buffer_load_dwordx4 a[80:83], v2, s[28:31], s56 offen offset:256 nt
  buffer_load_dwordx4 a[84:87], v2, s[28:31], s56 offen offset:320 nt
  buffer_load_dwordx4 a[88:91], v2, s[28:31], s56 offen offset:384 nt
  buffer_load_dwordx4 a[92:95], v2, s[28:31], s56 offen offset:448 nt
  s_waitcnt vmcnt(16)
  buffer_load_dwordx4 a[96:99], v3, s[32:35], s56 offen offset:0 nt
  buffer_load_dwordx4 a[100:103], v3, s[32:35], s56 offen offset:256 nt
  buffer_load_dwordx4 a[104:107], v3, s[32:35], s56 offen offset:512 nt
  buffer_load_dwordx4 a[108:111], v3, s[32:35], s56 offen offset:768 nt
  buffer_load_dwordx4 a[112:115], v3, s[32:35], s56 offen offset:1024 nt
  buffer_load_dwordx4 a[116:119], v3, s[32:35], s56 offen offset:1280 nt
  buffer_load_dwordx4 a[120:123], v3, s[32:35], s56 offen offset:1536 nt
  buffer_load_dwordx4 a[124:127], v3, s[32:35], s56 offen offset:1792 nt
  s_waitcnt vmcnt(16)
  s_add_u32 s56, s56, 196608
  buffer_load_dwordx4 a[128:131], v2, s[28:31], s56 offen offset:0 nt
  buffer_load_dwordx4 a[132:135], v2, s[28:31], s56 offen offset:64 nt
  buffer_load_dwordx4 a[136:139], v2, s[28:31], s56 offen offset:128 nt
  buffer_load_dwordx4 a[140:143], v2, s[28:31], s56 offen offset:192 nt
  buffer_load_dwordx4 a[144:147], v2, s[28:31], s56 offen offset:256 nt
  buffer_load_dwordx4 a[148:151], v2, s[28:31], s56 offen offset:320 nt
  buffer_load_dwordx4 a[152:155], v2, s[28:31], s56 offen offset:384 nt
  buffer_load_dwordx4 a[156:159], v2, s[28:31], s56 offen offset:448 nt
  s_waitcnt vmcnt(16)
  buffer_load_dwordx4 a[160:163], v3, s[32:35], s56 offen offset:0 nt
  buffer_load_dwordx4 a[164:167], v3, s[32:35], s56 offen offset:256 nt
  buffer_load_dwordx4 a[168:171], v3, s[32:35], s56 offen offset:512 nt
  buffer_load_dwordx4 a[172:175], v3, s[32:35], s56 offen offset:768 nt
  buffer_load_dwordx4 a[176:179], v3, s[32:35], s56 offen offset:1024 nt
  buffer_load_dwordx4 a[180:183], v3, s[32:35], s56 offen offset:1280 nt
  buffer_load_dwordx4 a[184:187], v3, s[32:35], s56 offen offset:1536 nt
  buffer_load_dwordx4 a[188:191], v3, s[32:35], s56 offen offset:1792 nt
  s_waitcnt vmcnt(16)
  s_add_u32 s56, s56, 196608
  buffer_load_dwordx4 a[192:195], v2, s[28:31], s56 offen offset:0 nt
  buffer_load_dwordx4 a[196:199], v2, s[28:31], s56 offen offset:64 nt
  buffer_load_dwordx4 a[200:203], v2, s[28:31], s56 offen offset:128 nt
  buffer_load_dwordx4 a[204:207], v2, s[28:31], s56 offen offset:192 nt
  buffer_load_dwordx4 a[208:211], v2, s[28:31], s56 offen offset:256 nt
  buffer_load_dwordx4 a[212:215], v2, s[28:31], s56 offen offset:320 nt
  buffer_load_dwordx4 a[216:219], v2, s[28:31], s56 offen offset:384 nt
  buffer_load_dwordx4 a[220:223], v2, s[28:31], s56 offen offset:448 nt
  s_waitcnt vmcnt(16)
  buffer_load_dwordx4 a[224:227], v3, s[32:35], s56 offen offset:0 nt
  buffer_load_dwordx4 a[228:231], v3, s[32:35], s56 offen offset:256 nt
  buffer_load_dwordx4 a[232:235], v3, s[32:35], s56 offen offset:512 nt
  buffer_load_dwordx4 a[236:239], v3, s[32:35], s56 offen offset:768 nt
  buffer_load_dwordx4 a[240:243], v3, s[32:35], s56 offen offset:1024 nt
  buffer_load_dwordx4 a[244:247], v3, s[32:35], s56 offen offset:1280 nt
  buffer_load_dwordx4 a[248:251], v3, s[32:35], s56 offen offset:1536 nt
  buffer_load_dwordx4 a[252:255], v3, s[32:35], s56 offen offset:1792 nt
  s_waitcnt vmcnt(16)
  s_add_u32 s56, s56, 196608
  buffer_load_dwordx4 v[96:99], v2, s[28:31], s56 offen offset:0 nt
  buffer_load_dwordx4 v[100:103], v2, s[28:31], s56 offen offset:64 nt
  buffer_load_dwordx4 v[104:107], v2, s[28:31], s56 offen offset:128 nt
  buffer_load_dwordx4 v[108:111], v2, s[28:31], s56 offen offset:192 nt
  buffer_load_dwordx4 v[112:115], v2, s[28:31], s56 offen offset:256 nt
  buffer_load_dwordx4 v[116:119], v2, s[28:31], s56 offen offset:320 nt
  buffer_load_dwordx4 v[120:123], v2, s[28:31], s56 offen offset:384 nt
  buffer_load_dwordx4 v[124:127], v2, s[28:31], s56 offen offset:448 nt
  s_waitcnt vmcnt(16)
  buffer_load_dwordx4 v[128:131], v3, s[32:35], s56 offen offset:0 nt
  buffer_load_dwordx4 v[132:135], v3, s[32:35], s56 offen offset:256 nt
  buffer_load_dwordx4 v[136:139], v3, s[32:35], s56 offen offset:512 nt
  buffer_load_dwordx4 v[140:143], v3, s[32:35], s56 offen offset:768 nt
  buffer_load_dwordx4 v[144:147], v3, s[32:35], s56 offen offset:1024 nt
  buffer_load_dwordx4 v[148:151], v3, s[32:35], s56 offen offset:1280 nt
  buffer_load_dwordx4 v[152:155], v3, s[32:35], s56 offen offset:1536 nt
  buffer_load_dwordx4 v[156:159], v3, s[32:35], s56 offen offset:1792 nt
  s_waitcnt vmcnt(16)
  s_add_u32 s56, s56, 196608
  buffer_load_dwordx4 v[160:163], v2, s[28:31], s56 offen offset:0 nt
  buffer_load_dwordx4 v[164:167], v2, s[28:31], s56 offen offset:64 nt
  buffer_load_dwordx4 v[168:171], v2, s[28:31], s56 offen offset:128 nt
  buffer_load_dwordx4 v[172:175], v2, s[28:31], s56 offen offset:192 nt
  buffer_load_dwordx4 v[176:179], v2, s[28:31], s56 offen offset:256 nt
  buffer_load_dwordx4 v[180:183], v2, s[28:31], s56 offen offset:320 nt
  buffer_load_dwordx4 v[184:187], v2, s[28:31], s56 offen offset:384 nt
  buffer_load_dwordx4 v[188:191], v2, s[28:31], s56 offen offset:448 nt
  s_waitcnt vmcnt(16)
  buffer_load_dwordx4 v[192:195], v3, s[32:35], s56 offen offset:0 nt
  buffer_load_dwordx4 v[196:199], v3, s[32:35], s56 offen offset:256 nt
  buffer_load_dwordx4 v[200:203], v3, s[32:35], s56 offen offset:512 nt
  buffer_load_dwordx4 v[204:207], v3, s[32:35], s56 offen offset:768 nt
  buffer_load_dwordx4 v[208:211], v3, s[32:35], s56 offen offset:1024 nt
  buffer_load_dwordx4 v[212:215], v3, s[32:35], s56 offen offset:1280 nt
  buffer_load_dwordx4 v[216:219], v3, s[32:35], s56 offen offset:1536 nt
  buffer_load_dwordx4 v[220:223], v3, s[32:35], s56 offen offset:1792 nt
  s_waitcnt vmcnt(16)
  s_add_u32 s56, s56, 196608
  buffer_load_dwordx4 v[224:227], v2, s[28:31], s56 offen offset:0 nt
  buffer_load_dwordx4 v[228:231], v2, s[28:31], s56 offen offset:64 nt
  buffer_load_dwordx4 v[232:235], v2, s[28:31], s56 offen offset:128 nt
  buffer_load_dwordx4 v[236:239], v2, s[28:31], s56 offen offset:192 nt
  buffer_load_dwordx4 v[240:243], v2, s[28:31], s56 offen offset:256 nt
  buffer_load_dwordx4 v[244:247], v2, s[28:31], s56 offen offset:320 nt
  buffer_load_dwordx4 v[248:251], v2, s[28:31], s56 offen offset:384 nt
  buffer_load_dwordx4 v[252:255], v2, s[28:31], s56 offen offset:448 nt
  v_and_b32 v28, 1, v1
  v_cmp_eq_u32 vcc, 1, v28
  v_mov_b32 v26, 0xffff
  v_mov_b32 v27, 0xffff0000
  v_cndmask_b32 v26, v26, v27, vcc
  v_bfe_u32 v28, v1, 1, 2
  v_cmp_eq_u32 vcc, 0, v28
  s_nop 1
  v_cndmask_b32 v4, 0, v26, vcc
  v_cmp_eq_u32 vcc, 1, v28
  s_nop 1
  v_cndmask_b32 v5, 0, v26, vcc
  v_cmp_eq_u32 vcc, 2, v28
  s_nop 1
  v_cndmask_b32 v6, 0, v26, vcc
  v_cmp_eq_u32 vcc, 3, v28
  s_nop 1
  v_cndmask_b32 v7, 0, v26, vcc
  v_mov_b32 v20, 0xf149f2ca
  v_mov_b32 v21, 0
  v_mov_b32 v12, 0
  v_mov_b32 v13, 0
  v_mov_b32 v14, 0
  v_mov_b32 v15, 0
  v_mov_b32 v16, 0
  v_mov_b32 v17, 0
  v_mov_b32 v18, 0
  v_mov_b32 v19, 0
  s_lshr_b32 s49, 6, s46
  s_and_b32 s64, s49, 1
  s_mov_b32 s65, 0
  s_lshl_b32 s49, 1, s46
  s_sub_u32 s49, s49, 1
  s_and_b32 s49, s49, 6
  s_bcnt1_i32_b32 s49, s49
  s_mul_i32 s93, s95, 2
  s_add_u32 s93, s93, s49
  s_add_u32 s93, s93, 168
  s_lshl_b32 s93, s93, 13
  s_cmp_eq_u32 s64, 1
  s_cselect_b32 s93, s93, 8388608
  v_mov_b32 v84, 1024
  v_mov_b32 v83, 1
  s_mov_b32 s94, 0x3db8aa3b
  s_waitcnt lgkmcnt(0)
  s_mul_i32 s47, s48, 0x9E3779B1
  s_add_u32 s47, s47, 0x7F4A7C15
  v_mov_b32 v25, 1028
  s_mov_b32 s66, 0
L_wq:
  ds_read_b32 v24, v25
  s_waitcnt lgkmcnt(0)
  v_readfirstlane_b32 s49, v24
  s_nop 0
  s_cmp_eq_u32 s49, 1
  s_cbranch_scc1 L_barB
  s_sleep 2
  s_add_u32 s66, s66, 1
  s_cmp_lt_u32 s66, 1048576
  s_cbranch_scc1 L_wq
  s_branch L_barB
L_helper1:
  s_setprio 3
  v_mov_b32 v22, 1028
  v_mov_b32 v24, 0
  ds_write_b32 v22, v24
  s_lshr_b32 s54, s2, 3
  s_lshl_b32 s54, s54, 2
  s_add_u32 s54, s54, s95
  s_lshr_b32 s49, s54, 1
  s_lshl_b32 s49, s49, 7
  s_lshl_b32 s52, s54, 9
  s_add_u32 s52, s52, 65536
  s_and_b32 s53, s54, 1
  s_mov_b32 s50, 8192
  s_sub_u32 s51, 3670016, s49
  s_cmp_lt_u32 s95, 4
  s_cselect_b32 s51, s51, 0
  v_lshrrev_b32 v22, 3, v1
  v_mul_lo_u32 v22, v22, s50
  v_and_b32 v23, 7, v1
  v_lshl_add_u32 v22, v23, 4, v22
  v_lshlrev_b32 v24, 1, v1
  s_mul_i32 s56, s53, 224
  s_mul_i32 s56, s56, s50
  s_lshl_b32 s57, s50, 3
  s_waitcnt lgkmcnt(0)
  s_load_dword s48, s[26:27], 0
  s_add_u32 s40, s10, s49
  s_addc_u32 s41, s11, 0
  s_mov_b32 s42, s51
  s_mov_b32 s43, 0x00020000
  s_mov_b32 s36, s4
  s_mov_b32 s37, s5
  s_mov_b32 s38, 896
  s_mov_b32 s39, 0x00020000
  buffer_load_ushort v8, v24, s[36:39], 0 offen offset:0
  buffer_load_ushort v9, v24, s[36:39], 0 offen offset:128
  buffer_load_ushort v10, v24, s[36:39], 0 offen offset:256
  buffer_load_ushort v11, v24, s[36:39], 0 offen offset:384
  buffer_load_ushort v12, v24, s[36:39], 0 offen offset:512
  buffer_load_ushort v13, v24, s[36:39], 0 offen offset:640
  buffer_load_ushort v14, v24, s[36:39], 0 offen offset:768
  buffer_load_dwordx4 v[144:147], v22, s[40:43], s56 offen nt
  s_add_u32 s56, s56, s57
  buffer_load_dwordx4 v[148:151], v22, s[40:43], s56 offen nt
  s_add_u32 s56, s56, s57
  buffer_load_dwordx4 v[152:155], v22, s[40:43], s56 offen nt
  s_add_u32 s56, s56, s57
  buffer_load_dwordx4 v[156:159], v22, s[40:43], s56 offen nt
  s_add_u32 s56, s56, s57
  buffer_load_dwordx4 v[160:163], v22, s[40:43], s56 offen nt
  s_add_u32 s56, s56, s57
  buffer_load_dwordx4 v[164:167], v22, s[40:43], s56 offen nt
  s_add_u32 s56, s56, s57
  buffer_load_dwordx4 v[168:171], v22, s[40:43], s56 offen nt
  s_add_u32 s56, s56, s57
  buffer_load_dwordx4 v[172:175], v22, s[40:43], s56 offen nt
  s_add_u32 s56, s56, s57
  buffer_load_dwordx4 v[176:179], v22, s[40:43], s56 offen nt
  s_add_u32 s56, s56, s57
  buffer_load_dwordx4 v[180:183], v22, s[40:43], s56 offen nt
  s_add_u32 s56, s56, s57
  buffer_load_dwordx4 v[184:187], v22, s[40:43], s56 offen nt
  s_add_u32 s56, s56, s57
  buffer_load_dwordx4 v[188:191], v22, s[40:43], s56 offen nt
  s_add_u32 s56, s56, s57
  buffer_load_dwordx4 v[192:195], v22, s[40:43], s56 offen nt
  s_add_u32 s56, s56, s57
  buffer_load_dwordx4 v[196:199], v22, s[40:43], s56 offen nt
  s_add_u32 s56, s56, s57
  buffer_load_dwordx4 v[200:203], v22, s[40:43], s56 offen nt
  s_add_u32 s56, s56, s57
  buffer_load_dwordx4 v[204:207], v22, s[40:43], s56 offen nt
  s_add_u32 s56, s56, s57
  buffer_load_dwordx4 v[208:211], v22, s[40:43], s56 offen nt
  s_add_u32 s56, s56, s57
  buffer_load_dwordx4 v[212:215], v22, s[40:43], s56 offen nt
  s_add_u32 s56, s56, s57
  buffer_load_dwordx4 v[216:219], v22, s[40:43], s56 offen nt
  s_add_u32 s56, s56, s57
  buffer_load_dwordx4 v[220:223], v22, s[40:43], s56 offen nt
  s_add_u32 s56, s56, s57
  buffer_load_dwordx4 v[224:227], v22, s[40:43], s56 offen nt
  s_add_u32 s56, s56, s57
  buffer_load_dwordx4 v[228:231], v22, s[40:43], s56 offen nt
  s_add_u32 s56, s56, s57
  buffer_load_dwordx4 v[232:235], v22, s[40:43], s56 offen nt
  s_add_u32 s56, s56, s57
  buffer_load_dwordx4 v[236:239], v22, s[40:43], s56 offen nt
  s_add_u32 s56, s56, s57
  buffer_load_dwordx4 v[240:243], v22, s[40:43], s56 offen nt
  s_add_u32 s56, s56, s57
  buffer_load_dwordx4 v[244:247], v22, s[40:43], s56 offen nt
  s_add_u32 s56, s56, s57
  buffer_load_dwordx4 v[248:251], v22, s[40:43], s56 offen nt
  s_add_u32 s56, s56, s57
  buffer_load_dwordx4 v[252:255], v22, s[40:43], s56 offen nt
  s_waitcnt lgkmcnt(0)
  s_barrier
  s_mul_i32 s47, s48, 0x9E3779B1
  s_add_u32 s47, s47, 0x7F4A7C15
  s_lshr_b32 s48, s2, 3
  s_cmp_lt_u32 s48, 28
  s_cselect_b32 s58, 7, 8
  s_mov_b32 s60, 968
  s_cselect_b32 s60, 896, s60
  s_cselect_b32 s61, 1, 0
  s_cmp_gt_u32 s95, 4
  s_cselect_b32 s59, s61, 0
  s_sub_u32 s59, s95, s59
  s_cmp_eq_u32 s95, 4
  s_cselect_b32 s61, s61, 0
  s_cmp_eq_u32 s61, 1
  s_mov_b32 s92, 88
  s_cselect_b32 s92, 16, s92
  s_cmp_eq_u32 s95, 0
  s_cbranch_scc0 L_noctinit
  s_lshr_b32 s48, s2, 3
  s_lshl_b32 s48, s48, 8
  s_add_u32 s48, s48, 32768
  s_add_u32 s96, s26, s48
  s_addc_u32 s97, s27, 0
  s_mov_b32 s98, 8
  s_mov_b32 s99, 0x00020000
  v_mov_b32 v30, s60
  v_mov_b32 v31, s47
  v_mov_b32 v29, 0
  s_mov_b64 exec, 1
  buffer_store_dwordx2 v[30:31], v29, s[96:99], 0 offen sc1
  s_mov_b64 exec, -1
  s_waitcnt vmcnt(29)
  s_branch L_ctdone
L_noctinit:
  s_waitcnt vmcnt(28)
L_ctdone:
  v_lshlrev_b32 v8, 16, v8
  v_lshlrev_b32 v9, 16, v9
  v_lshlrev_b32 v10, 16, v10
  v_lshlrev_b32 v11, 16, v11
  v_lshlrev_b32 v12, 16, v12
  v_lshlrev_b32 v13, 16, v13
  v_lshlrev_b32 v14, 16, v14
  v_add_f32 v32, v8, v9
  v_add_f32 v32, v32, v10
  v_add_f32 v32, v32, v11
  v_add_f32 v32, v32, v12
  v_add_f32 v32, v32, v13
  v_add_f32 v32, v32, v14
  s_nop 1
  v_add_f32_dpp v32, v32, v32 quad_perm:[1,0,3,2] row_mask:0xf bank_mask:0xf
  s_nop 1
  v_add_f32_dpp v32, v32, v32 quad_perm:[2,3,0,1] row_mask:0xf bank_mask:0xf
  s_nop 1
  v_add_f32_dpp v32, v32, v32 row_half_mirror row_mask:0xf bank_mask:0xf
  s_nop 1
  v_add_f32_dpp v32, v32, v32 row_mirror row_mask:0xf bank_mask:0xf
  s_nop 1
  v_mov_b32 v33, v32
  s_nop 1
  v_permlane16_swap_b32 v32, v33
  s_nop 1
  v_add_f32 v32, v32, v33
  v_mov_b32 v33, v32
  s_nop 1
  v_permlane32_swap_b32 v32, v33
  s_nop 1
  v_add_f32 v32, v32, v33
  v_mul_f32 v32, 0x3b124925, v32
  v_sub_f32 v34, v8, v32
  v_mul_f32 v35, v34, v34
  v_sub_f32 v34, v9, v32
  v_fmac_f32 v35, v34, v34
  v_sub_f32 v34, v10, v32
  v_fmac_f32 v35, v34, v34
  v_sub_f32 v34, v11, v32
  v_fmac_f32 v35, v34, v34
  v_sub_f32 v34, v12, v32
  v_fmac_f32 v35, v34, v34
  v_sub_f32 v34, v13, v32
  v_fmac_f32 v35, v34, v34
  v_sub_f32 v34, v14, v32
  v_fmac_f32 v35, v34, v34
  s_nop 1
  v_add_f32_dpp v35, v35, v35 quad_perm:[1,0,3,2] row_mask:0xf bank_mask:0xf
  s_nop 1
  v_add_f32_dpp v35, v35, v35 quad_perm:[2,3,0,1] row_mask:0xf bank_mask:0xf
  s_nop 1
  v_add_f32_dpp v35, v35, v35 row_half_mirror row_mask:0xf bank_mask:0xf
  s_nop 1
  v_add_f32_dpp v35, v35, v35 row_mirror row_mask:0xf bank_mask:0xf
  s_nop 1
  v_mov_b32 v33, v35
  s_nop 1
  v_permlane16_swap_b32 v35, v33
  s_nop 1
  v_add_f32 v35, v35, v33
  v_mov_b32 v33, v35
  s_nop 1
  v_permlane32_swap_b32 v35, v33
  s_nop 1
  v_add_f32 v35, v35, v33
  v_mul_f32 v35, 0x3b124925, v35
  v_cvt_pk_bf16_f32 v35, v35, v35
  v_lshlrev_b32 v35, 16, v35
  v_add_f32 v35, 0x3727c5ac, v35
  v_cvt_pk_bf16_f32 v35, v35, v35
  v_lshlrev_b32 v35, 16, v35
  v_sqrt_f32 v35, v35
  s_nop 0
  v_cvt_pk_bf16_f32 v35, v35, v35
  v_lshlrev_b32 v35, 16, v35
  v_cvt_pk_bf16_f32 v32, v32, v32
  v_lshlrev_b32 v32, 16, v32
  v_rcp_f32 v36, v35
  s_nop 0
  v_sub_f32 v8, v8, v32
  v_cvt_pk_bf16_f32 v8, v8, v8
  v_lshlrev_b32 v8, 16, v8
  v_mul_f32 v37, v8, v36
  v_fma_f32 v8, -v37, v35, v8
  v_fma_f32 v8, v8, v36, v37
  v_cvt_pk_bf16_f32 v8, v8, v8
  v_lshlrev_b32 v8, 16, v8
  v_sub_f32 v9, v9, v32
  v_cvt_pk_bf16_f32 v9, v9, v9
  v_lshlrev_b32 v9, 16, v9
  v_mul_f32 v37, v9, v36
  v_fma_f32 v9, -v37, v35, v9
  v_fma_f32 v9, v9, v36, v37
  v_cvt_pk_bf16_f32 v9, v9, v9
  v_lshlrev_b32 v9, 16, v9
  v_sub_f32 v10, v10, v32
  v_cvt_pk_bf16_f32 v10, v10, v10
  v_lshlrev_b32 v10, 16, v10
  v_mul_f32 v37, v10, v36
  v_fma_f32 v10, -v37, v35, v10
  v_fma_f32 v10, v10, v36, v37
  v_cvt_pk_bf16_f32 v10, v10, v10
  v_lshlrev_b32 v10, 16, v10
  v_sub_f32 v11, v11, v32
  v_cvt_pk_bf16_f32 v11, v11, v11
  v_lshlrev_b32 v11, 16, v11
  v_mul_f32 v37, v11, v36
  v_fma_f32 v11, -v37, v35, v11
  v_fma_f32 v11, v11, v36, v37
  v_cvt_pk_bf16_f32 v11, v11, v11
  v_lshlrev_b32 v11, 16, v11
  v_sub_f32 v12, v12, v32
  v_cvt_pk_bf16_f32 v12, v12, v12
  v_lshlrev_b32 v12, 16, v12
  v_mul_f32 v37, v12, v36
  v_fma_f32 v12, -v37, v35, v12
  v_fma_f32 v12, v12, v36, v37
  v_cvt_pk_bf16_f32 v12, v12, v12
  v_lshlrev_b32 v12, 16, v12
  v_sub_f32 v13, v13, v32
  v_cvt_pk_bf16_f32 v13, v13, v13
  v_lshlrev_b32 v13, 16, v13
  v_mul_f32 v37, v13, v36
  v_fma_f32 v13, -v37, v35, v13
  v_fma_f32 v13, v13, v36, v37
  v_cvt_pk_bf16_f32 v13, v13, v13
  v_lshlrev_b32 v13, 16, v13
  v_sub_f32 v14, v14, v32
  v_cvt_pk_bf16_f32 v14, v14, v14
  v_lshlrev_b32 v14, 16, v14
  v_mul_f32 v37, v14, v36
  v_fma_f32 v14, -v37, v35, v14
  v_fma_f32 v14, v14, v36, v37
  v_cvt_pk_bf16_f32 v14, v14, v14
  v_lshlrev_b32 v14, 16, v14
  v_lshlrev_b32 v25, 2, v1
  ds_write_b32 v25, v8 offset:2048
  ds_write_b32 v25, v9 offset:2304
  ds_write_b32 v25, v10 offset:2560
  ds_write_b32 v25, v11 offset:2816
  ds_write_b32 v25, v12 offset:3072
  ds_write_b32 v25, v13 offset:3328
  ds_write_b32 v25, v14 offset:3584
  v_lshrrev_b32 v25, 3, v1
  v_lshlrev_b32 v25, 2, v25
  s_mul_i32 s56, s53, 896
  v_add_u32 v25, s56, v25
  s_waitcnt lgkmcnt(0)
  ds_read_b32 v36, v25 offset:2048
  ds_read_b32 v37, v25 offset:2080
  ds_read_b32 v38, v25 offset:2112
  ds_read_b32 v39, v25 offset:2144
  ds_read_b32 v40, v25 offset:2176
  ds_read_b32 v41, v25 offset:2208
  ds_read_b32 v42, v25 offset:2240
  ds_read_b32 v43, v25 offset:2272
  ds_read_b32 v44, v25 offset:2304
  ds_read_b32 v45, v25 offset:2336
  ds_read_b32 v46, v25 offset:2368
  ds_read_b32 v47, v25 offset:2400
  ds_read_b32 v48, v25 offset:2432
  ds_read_b32 v49, v25 offset:2464
  ds_read_b32 v50, v25 offset:2496
  ds_read_b32 v51, v25 offset:2528
  ds_read_b32 v52, v25 offset:2560
  ds_read_b32 v53, v25 offset:2592
  ds_read_b32 v54, v25 offset:2624
  ds_read_b32 v55, v25 offset:2656
  ds_read_b32 v56, v25 offset:2688
  ds_read_b32 v57, v25 offset:2720
  ds_read_b32 v58, v25 offset:2752
  ds_read_b32 v59, v25 offset:2784
  ds_read_b32 v60, v25 offset:2816
  ds_read_b32 v61, v25 offset:2848
  ds_read_b32 v62, v25 offset:2880
  ds_read_b32 v63, v25 offset:2912
  v_mov_b32 v64, 0
  v_mov_b32 v65, 0
  v_mov_b32 v66, 0
  v_mov_b32 v67, 0
  v_mov_b32 v68, 0
  v_mov_b32 v69, 0
  v_mov_b32 v70, 0
  v_mov_b32 v71, 0
  s_waitcnt lgkmcnt(0)
  s_waitcnt vmcnt(27)
  v_lshrrev_b32 v26, 16, v36
  v_dot2c_f32_bf16 v64, v144, v26
  v_dot2c_f32_bf16 v65, v144, v36
  v_dot2c_f32_bf16 v66, v145, v26
  v_dot2c_f32_bf16 v67, v145, v36
  v_dot2c_f32_bf16 v68, v146, v26
  v_dot2c_f32_bf16 v69, v146, v36
  v_dot2c_f32_bf16 v70, v147, v26
  v_dot2c_f32_bf16 v71, v147, v36
  s_waitcnt vmcnt(26)
  v_lshrrev_b32 v26, 16, v37
  v_dot2c_f32_bf16 v64, v148, v26
  v_dot2c_f32_bf16 v65, v148, v37
  v_dot2c_f32_bf16 v66, v149, v26
  v_dot2c_f32_bf16 v67, v149, v37
  v_dot2c_f32_bf16 v68, v150, v26
  v_dot2c_f32_bf16 v69, v150, v37
  v_dot2c_f32_bf16 v70, v151, v26
  v_dot2c_f32_bf16 v71, v151, v37
  s_waitcnt vmcnt(25)
  v_lshrrev_b32 v26, 16, v38
  v_dot2c_f32_bf16 v64, v152, v26
  v_dot2c_f32_bf16 v65, v152, v38
  v_dot2c_f32_bf16 v66, v153, v26
  v_dot2c_f32_bf16 v67, v153, v38
  v_dot2c_f32_bf16 v68, v154, v26
  v_dot2c_f32_bf16 v69, v154, v38
  v_dot2c_f32_bf16 v70, v155, v26
  v_dot2c_f32_bf16 v71, v155, v38
  s_waitcnt vmcnt(24)
  v_lshrrev_b32 v26, 16, v39
  v_dot2c_f32_bf16 v64, v156, v26
  v_dot2c_f32_bf16 v65, v156, v39
  v_dot2c_f32_bf16 v66, v157, v26
  v_dot2c_f32_bf16 v67, v157, v39
  v_dot2c_f32_bf16 v68, v158, v26
  v_dot2c_f32_bf16 v69, v158, v39
  v_dot2c_f32_bf16 v70, v159, v26
  v_dot2c_f32_bf16 v71, v159, v39
  s_waitcnt vmcnt(23)
  v_lshrrev_b32 v26, 16, v40
  v_dot2c_f32_bf16 v64, v160, v26
  v_dot2c_f32_bf16 v65, v160, v40
  v_dot2c_f32_bf16 v66, v161, v26
  v_dot2c_f32_bf16 v67, v161, v40
  v_dot2c_f32_bf16 v68, v162, v26
  v_dot2c_f32_bf16 v69, v162, v40
  v_dot2c_f32_bf16 v70, v163, v26
  v_dot2c_f32_bf16 v71, v163, v40
  s_waitcnt vmcnt(22)
  v_lshrrev_b32 v26, 16, v41
  v_dot2c_f32_bf16 v64, v164, v26
  v_dot2c_f32_bf16 v65, v164, v41
  v_dot2c_f32_bf16 v66, v165, v26
  v_dot2c_f32_bf16 v67, v165, v41
  v_dot2c_f32_bf16 v68, v166, v26
  v_dot2c_f32_bf16 v69, v166, v41
  v_dot2c_f32_bf16 v70, v167, v26
  v_dot2c_f32_bf16 v71, v167, v41
  s_waitcnt vmcnt(21)
  v_lshrrev_b32 v26, 16, v42
  v_dot2c_f32_bf16 v64, v168, v26
  v_dot2c_f32_bf16 v65, v168, v42
  v_dot2c_f32_bf16 v66, v169, v26
  v_dot2c_f32_bf16 v67, v169, v42
  v_dot2c_f32_bf16 v68, v170, v26
  v_dot2c_f32_bf16 v69, v170, v42
  v_dot2c_f32_bf16 v70, v171, v26
  v_dot2c_f32_bf16 v71, v171, v42
  s_waitcnt vmcnt(20)
  v_lshrrev_b32 v26, 16, v43
  v_dot2c_f32_bf16 v64, v172, v26
  v_dot2c_f32_bf16 v65, v172, v43
  v_dot2c_f32_bf16 v66, v173, v26
  v_dot2c_f32_bf16 v67, v173, v43
  v_dot2c_f32_bf16 v68, v174, v26
  v_dot2c_f32_bf16 v69, v174, v43
  v_dot2c_f32_bf16 v70, v175, v26
  v_dot2c_f32_bf16 v71, v175, v43
  s_waitcnt vmcnt(19)
  v_lshrrev_b32 v26, 16, v44
  v_dot2c_f32_bf16 v64, v176, v26
  v_dot2c_f32_bf16 v65, v176, v44
  v_dot2c_f32_bf16 v66, v177, v26
  v_dot2c_f32_bf16 v67, v177, v44
  v_dot2c_f32_bf16 v68, v178, v26
  v_dot2c_f32_bf16 v69, v178, v44
  v_dot2c_f32_bf16 v70, v179, v26
  v_dot2c_f32_bf16 v71, v179, v44
  s_waitcnt vmcnt(18)
  v_lshrrev_b32 v26, 16, v45
  v_dot2c_f32_bf16 v64, v180, v26
  v_dot2c_f32_bf16 v65, v180, v45
  v_dot2c_f32_bf16 v66, v181, v26
  v_dot2c_f32_bf16 v67, v181, v45
  v_dot2c_f32_bf16 v68, v182, v26
  v_dot2c_f32_bf16 v69, v182, v45
  v_dot2c_f32_bf16 v70, v183, v26
  v_dot2c_f32_bf16 v71, v183, v45
  s_waitcnt vmcnt(17)
  v_lshrrev_b32 v26, 16, v46
  v_dot2c_f32_bf16 v64, v184, v26
  v_dot2c_f32_bf16 v65, v184, v46
  v_dot2c_f32_bf16 v66, v185, v26
  v_dot2c_f32_bf16 v67, v185, v46
  v_dot2c_f32_bf16 v68, v186, v26
  v_dot2c_f32_bf16 v69, v186, v46
  v_dot2c_f32_bf16 v70, v187, v26
  v_dot2c_f32_bf16 v71, v187, v46
  s_waitcnt vmcnt(16)
  v_lshrrev_b32 v26, 16, v47
  v_dot2c_f32_bf16 v64, v188, v26
  v_dot2c_f32_bf16 v65, v188, v47
  v_dot2c_f32_bf16 v66, v189, v26
  v_dot2c_f32_bf16 v67, v189, v47
  v_dot2c_f32_bf16 v68, v190, v26
  v_dot2c_f32_bf16 v69, v190, v47
  v_dot2c_f32_bf16 v70, v191, v26
  v_dot2c_f32_bf16 v71, v191, v47
  s_waitcnt vmcnt(15)
  v_lshrrev_b32 v26, 16, v48
  v_dot2c_f32_bf16 v64, v192, v26
  v_dot2c_f32_bf16 v65, v192, v48
  v_dot2c_f32_bf16 v66, v193, v26
  v_dot2c_f32_bf16 v67, v193, v48
  v_dot2c_f32_bf16 v68, v194, v26
  v_dot2c_f32_bf16 v69, v194, v48
  v_dot2c_f32_bf16 v70, v195, v26
  v_dot2c_f32_bf16 v71, v195, v48
  s_waitcnt vmcnt(14)
  v_lshrrev_b32 v26, 16, v49
  v_dot2c_f32_bf16 v64, v196, v26
  v_dot2c_f32_bf16 v65, v196, v49
  v_dot2c_f32_bf16 v66, v197, v26
  v_dot2c_f32_bf16 v67, v197, v49
  v_dot2c_f32_bf16 v68, v198, v26
  v_dot2c_f32_bf16 v69, v198, v49
  v_dot2c_f32_bf16 v70, v199, v26
  v_dot2c_f32_bf16 v71, v199, v49
  s_waitcnt vmcnt(13)
  v_lshrrev_b32 v26, 16, v50
  v_dot2c_f32_bf16 v64, v200, v26
  v_dot2c_f32_bf16 v65, v200, v50
  v_dot2c_f32_bf16 v66, v201, v26
  v_dot2c_f32_bf16 v67, v201, v50
  v_dot2c_f32_bf16 v68, v202, v26
  v_dot2c_f32_bf16 v69, v202, v50
  v_dot2c_f32_bf16 v70, v203, v26
  v_dot2c_f32_bf16 v71, v203, v50
  s_waitcnt vmcnt(12)
  v_lshrrev_b32 v26, 16, v51
  v_dot2c_f32_bf16 v64, v204, v26
  v_dot2c_f32_bf16 v65, v204, v51
  v_dot2c_f32_bf16 v66, v205, v26
  v_dot2c_f32_bf16 v67, v205, v51
  v_dot2c_f32_bf16 v68, v206, v26
  v_dot2c_f32_bf16 v69, v206, v51
  v_dot2c_f32_bf16 v70, v207, v26
  v_dot2c_f32_bf16 v71, v207, v51
  s_waitcnt vmcnt(11)
  v_lshrrev_b32 v26, 16, v52
  v_dot2c_f32_bf16 v64, v208, v26
  v_dot2c_f32_bf16 v65, v208, v52
  v_dot2c_f32_bf16 v66, v209, v26
  v_dot2c_f32_bf16 v67, v209, v52
  v_dot2c_f32_bf16 v68, v210, v26
  v_dot2c_f32_bf16 v69, v210, v52
  v_dot2c_f32_bf16 v70, v211, v26
  v_dot2c_f32_bf16 v71, v211, v52
  s_waitcnt vmcnt(10)
  v_lshrrev_b32 v26, 16, v53
  v_dot2c_f32_bf16 v64, v212, v26
  v_dot2c_f32_bf16 v65, v212, v53
  v_dot2c_f32_bf16 v66, v213, v26
  v_dot2c_f32_bf16 v67, v213, v53
  v_dot2c_f32_bf16 v68, v214, v26
  v_dot2c_f32_bf16 v69, v214, v53
  v_dot2c_f32_bf16 v70, v215, v26
  v_dot2c_f32_bf16 v71, v215, v53
  s_waitcnt vmcnt(9)
  v_lshrrev_b32 v26, 16, v54
  v_dot2c_f32_bf16 v64, v216, v26
  v_dot2c_f32_bf16 v65, v216, v54
  v_dot2c_f32_bf16 v66, v217, v26
  v_dot2c_f32_bf16 v67, v217, v54
  v_dot2c_f32_bf16 v68, v218, v26
  v_dot2c_f32_bf16 v69, v218, v54
  v_dot2c_f32_bf16 v70, v219, v26
  v_dot2c_f32_bf16 v71, v219, v54
  s_waitcnt vmcnt(8)
  v_lshrrev_b32 v26, 16, v55
  v_dot2c_f32_bf16 v64, v220, v26
  v_dot2c_f32_bf16 v65, v220, v55
  v_dot2c_f32_bf16 v66, v221, v26
  v_dot2c_f32_bf16 v67, v221, v55
  v_dot2c_f32_bf16 v68, v222, v26
  v_dot2c_f32_bf16 v69, v222, v55
  v_dot2c_f32_bf16 v70, v223, v26
  v_dot2c_f32_bf16 v71, v223, v55
  s_waitcnt vmcnt(7)
  v_lshrrev_b32 v26, 16, v56
  v_dot2c_f32_bf16 v64, v224, v26
  v_dot2c_f32_bf16 v65, v224, v56
  v_dot2c_f32_bf16 v66, v225, v26
  v_dot2c_f32_bf16 v67, v225, v56
  v_dot2c_f32_bf16 v68, v226, v26
  v_dot2c_f32_bf16 v69, v226, v56
  v_dot2c_f32_bf16 v70, v227, v26
  v_dot2c_f32_bf16 v71, v227, v56
  s_waitcnt vmcnt(6)
  v_lshrrev_b32 v26, 16, v57
  v_dot2c_f32_bf16 v64, v228, v26
  v_dot2c_f32_bf16 v65, v228, v57
  v_dot2c_f32_bf16 v66, v229, v26
  v_dot2c_f32_bf16 v67, v229, v57
  v_dot2c_f32_bf16 v68, v230, v26
  v_dot2c_f32_bf16 v69, v230, v57
  v_dot2c_f32_bf16 v70, v231, v26
  v_dot2c_f32_bf16 v71, v231, v57
  s_waitcnt vmcnt(5)
  v_lshrrev_b32 v26, 16, v58
  v_dot2c_f32_bf16 v64, v232, v26
  v_dot2c_f32_bf16 v65, v232, v58
  v_dot2c_f32_bf16 v66, v233, v26
  v_dot2c_f32_bf16 v67, v233, v58
  v_dot2c_f32_bf16 v68, v234, v26
  v_dot2c_f32_bf16 v69, v234, v58
  v_dot2c_f32_bf16 v70, v235, v26
  v_dot2c_f32_bf16 v71, v235, v58
  s_waitcnt vmcnt(4)
  v_lshrrev_b32 v26, 16, v59
  v_dot2c_f32_bf16 v64, v236, v26
  v_dot2c_f32_bf16 v65, v236, v59
  v_dot2c_f32_bf16 v66, v237, v26
  v_dot2c_f32_bf16 v67, v237, v59
  v_dot2c_f32_bf16 v68, v238, v26
  v_dot2c_f32_bf16 v69, v238, v59
  v_dot2c_f32_bf16 v70, v239, v26
  v_dot2c_f32_bf16 v71, v239, v59
  s_waitcnt vmcnt(3)
  v_lshrrev_b32 v26, 16, v60
  v_dot2c_f32_bf16 v64, v240, v26
  v_dot2c_f32_bf16 v65, v240, v60
  v_dot2c_f32_bf16 v66, v241, v26
  v_dot2c_f32_bf16 v67, v241, v60
  v_dot2c_f32_bf16 v68, v242, v26
  v_dot2c_f32_bf16 v69, v242, v60
  v_dot2c_f32_bf16 v70, v243, v26
  v_dot2c_f32_bf16 v71, v243, v60
  s_waitcnt vmcnt(2)
  v_lshrrev_b32 v26, 16, v61
  v_dot2c_f32_bf16 v64, v244, v26
  v_dot2c_f32_bf16 v65, v244, v61
  v_dot2c_f32_bf16 v66, v245, v26
  v_dot2c_f32_bf16 v67, v245, v61
  v_dot2c_f32_bf16 v68, v246, v26
  v_dot2c_f32_bf16 v69, v246, v61
  v_dot2c_f32_bf16 v70, v247, v26
  v_dot2c_f32_bf16 v71, v247, v61
  s_waitcnt vmcnt(1)
  v_lshrrev_b32 v26, 16, v62
  v_dot2c_f32_bf16 v64, v248, v26
  v_dot2c_f32_bf16 v65, v248, v62
  v_dot2c_f32_bf16 v66, v249, v26
  v_dot2c_f32_bf16 v67, v249, v62
  v_dot2c_f32_bf16 v68, v250, v26
  v_dot2c_f32_bf16 v69, v250, v62
  v_dot2c_f32_bf16 v70, v251, v26
  v_dot2c_f32_bf16 v71, v251, v62
  s_waitcnt vmcnt(0)
  v_lshrrev_b32 v26, 16, v63
  v_dot2c_f32_bf16 v64, v252, v26
  v_dot2c_f32_bf16 v65, v252, v63
  v_dot2c_f32_bf16 v66, v253, v26
  v_dot2c_f32_bf16 v67, v253, v63
  v_dot2c_f32_bf16 v68, v254, v26
  v_dot2c_f32_bf16 v69, v254, v63
  v_dot2c_f32_bf16 v70, v255, v26
  v_dot2c_f32_bf16 v71, v255, v63
  s_nop 1
  v_permlane32_swap_b32 v64, v68
  v_permlane32_swap_b32 v65, v69
  v_permlane32_swap_b32 v66, v70
  v_permlane32_swap_b32 v67, v71
  s_nop 1
  v_add_f32 v64, v64, v68
  v_add_f32 v65, v65, v69
  v_add_f32 v66, v66, v70
  v_add_f32 v67, v67, v71
  s_nop 1
  v_permlane16_swap_b32 v64, v66
  v_permlane16_swap_b32 v65, v67
  s_nop 1
  v_add_f32 v64, v64, v66
  v_add_f32 v65, v65, v67
  s_nop 1
  v_add_f32_dpp v64, v64, v64 row_ror:8 row_mask:0xf bank_mask:0xf
  v_add_f32_dpp v65, v65, v65 row_ror:8 row_mask:0xf bank_mask:0xf
  v_mov_b32 v68, v64
  v_mov_b32 v69, s47
  v_mov_b32 v70, v65
  v_mov_b32 v71, s47
  v_and_b32 v25, 7, v1
  v_lshlrev_b32 v25, 6, v25
  v_lshrrev_b32 v26, 4, v1
  v_lshl_add_u32 v25, v26, 4, v25
  s_cmp_lt_u32 s95, 4
  s_cbranch_scc0 L_nopub
  s_add_u32 s36, s26, s52
  s_addc_u32 s37, s27, 0
  s_mov_b32 s38, 512
  s_mov_b32 s39, 0x00020000
  s_mov_b32 s68, 0x00ff00ff
  s_mov_b32 s69, 0x00ff00ff
  s_mov_b64 exec, s[68:69]
  buffer_store_dwordx4 v[68:71], v25, s[36:39], 0 offen sc1
  s_mov_b64 exec, -1
L_nopub:
  v_lshlrev_b32 v25, 4, v1
  v_mov_b32 v32, -1
  v_mov_b32 v33, -1
  v_mov_b32 v34, -1
  v_mov_b32 v35, -1
  ds_write_b128 v25, v[32:35] offset:12288
  ds_write_b128 v25, v[32:35] offset:13312
  ds_write_b128 v25, v[32:35] offset:14336
  ds_write_b128 v25, v[32:35] offset:15360
  v_lshlrev_b32 v25, 2, v1
  ds_write_b32 v25, v32 offset:16384
  ds_write_b32 v25, v32 offset:16640
  s_add_u32 s48, s95, 264
  s_add_u32 s59, s59, 392
  v_add_u32 v36, 0, v1
  v_lshlrev_b32 v26, 3, v36
  v_add_u32 v26, s48, v26
  v_subrev_u32 v37, 16, v36
  v_mul_lo_u32 v37, v37, s58
  v_add_u32 v37, s59, v37
  v_cmp_gt_u32 vcc, 16, v36
  s_nop 1
  v_cndmask_b32 v26, v37, v26, vcc
  v_cmp_gt_u32 vcc, s92, v36
  s_nop 1
  v_cndmask_b32 v26, v32, v26, vcc
  ds_write_b32 v25, v26 offset:12288
  v_add_u32 v36, 64, v1
  v_lshlrev_b32 v26, 3, v36
  v_add_u32 v26, s48, v26
  v_subrev_u32 v37, 16, v36
  v_mul_lo_u32 v37, v37, s58
  v_add_u32 v37, s59, v37
  v_cmp_gt_u32 vcc, 16, v36
  s_nop 1
  v_cndmask_b32 v26, v37, v26, vcc
  v_cmp_gt_u32 vcc, s92, v36
  s_nop 1
  v_cndmask_b32 v26, v32, v26, vcc
  ds_write_b32 v25, v26 offset:12544
  v_mov_b32 v26, 0
  v_mov_b32 v25, 1024
  ds_write_b32 v25, v26
  s_lshl_b32 s49, s44, 13
  s_add_u32 s49, s49, 65536
  s_add_u32 s36, s26, s49
  s_addc_u32 s37, s27, 0
  s_mov_b32 s38, 8192
  s_mov_b32 s39, 0x00020000
  v_lshlrev_b32 v22, 4, v1
  s_mov_b32 s50, 4096
  s_mov_b32 s66, 0
L_pq_1:
  buffer_load_dwordx4 v[144:147], v22, s[36:39], 0 offen offset:0 sc1
  buffer_load_dwordx4 v[148:151], v22, s[36:39], 0 offen offset:1024 sc1
  buffer_load_dwordx4 v[152:155], v22, s[36:39], 0 offen offset:2048 sc1
  buffer_load_dwordx4 v[156:159], v22, s[36:39], 0 offen offset:3072 sc1
  buffer_load_dwordx4 v[160:163], v22, s[36:39], s50 offen offset:0 sc1
  buffer_load_dwordx4 v[164:167], v22, s[36:39], s50 offen offset:1024 sc1
  buffer_load_dwordx4 v[168:171], v22, s[36:39], s50 offen offset:2048 sc1
  buffer_load_dwordx4 v[172:175], v22, s[36:39], s50 offen offset:3072 sc1
  s_waitcnt vmcnt(0)
  v_xor_b32 v24, s47, v145
  v_xor_b32 v25, s47, v147
  v_or_b32 v24, v24, v25
  v_xor_b32 v25, s47, v149
  v_or_b32 v24, v24, v25
  v_xor_b32 v25, s47, v151
  v_or_b32 v24, v24, v25
  v_xor_b32 v25, s47, v153
  v_or_b32 v24, v24, v25
  v_xor_b32 v25, s47, v155
  v_or_b32 v24, v24, v25
  v_xor_b32 v25, s47, v157
  v_or_b32 v24, v24, v25
  v_xor_b32 v25, s47, v159
  v_or_b32 v24, v24, v25
  v_xor_b32 v25, s47, v161
  v_or_b32 v24, v24, v25
  v_xor_b32 v25, s47, v163
  v_or_b32 v24, v24, v25
  v_xor_b32 v25, s47, v165
  v_or_b32 v24, v24, v25
  v_xor_b32 v25, s47, v167
  v_or_b32 v24, v24, v25
  v_xor_b32 v25, s47, v169
  v_or_b32 v24, v24, v25
  v_xor_b32 v25, s47, v171
  v_or_b32 v24, v24, v25
  v_xor_b32 v25, s47, v173
  v_or_b32 v24, v24, v25
  v_xor_b32 v25, s47, v175
  v_or_b32 v24, v24, v25
  v_cmp_ne_u32 vcc, 0, v24
  s_nop 4
  s_cbranch_vccz L_pqok_2
  s_add_u32 s66, s66, 1
  s_cmp_lt_u32 s66, 65536
  s_sleep 1
  s_cbranch_scc1 L_pq_1
L_pqok_2:
  v_permlane32_swap_b32 v144, v146
  v_permlane32_swap_b32 v148, v150
  v_permlane32_swap_b32 v152, v154
  v_permlane32_swap_b32 v156, v158
  v_permlane32_swap_b32 v160, v162
  v_permlane32_swap_b32 v164, v166
  v_permlane32_swap_b32 v168, v170
  v_permlane32_swap_b32 v172, v174
  s_nop 1
  v_add_f32 v144, v144, v146
  v_add_f32 v148, v148, v150
  v_add_f32 v152, v152, v154
  v_add_f32 v156, v156, v158
  v_add_f32 v160, v160, v162
  v_add_f32 v164, v164, v166
  v_add_f32 v168, v168, v170
  v_add_f32 v172, v172, v174
  v_cvt_pk_bf16_f32 v144, v144, v144
  v_cvt_pk_bf16_f32 v148, v148, v148
  v_cvt_pk_bf16_f32 v152, v152, v152
  v_cvt_pk_bf16_f32 v156, v156, v156
  v_cvt_pk_bf16_f32 v160, v160, v160
  v_cvt_pk_bf16_f32 v164, v164, v164
  v_cvt_pk_bf16_f32 v168, v168, v168
  v_cvt_pk_bf16_f32 v172, v172, v172
  v_and_b32 v22, 31, v1
  v_lshlrev_b32 v22, 2, v22
  v_lshrrev_b32 v23, 5, v1
  v_lshl_add_u32 v22, v23, 1, v22
  ds_write_b16 v22, v144 offset:0
  ds_write_b16 v22, v148 offset:128
  ds_write_b16 v22, v152 offset:256
  ds_write_b16 v22, v156 offset:384
  ds_write_b16 v22, v160 offset:512
  ds_write_b16 v22, v164 offset:640
  ds_write_b16 v22, v168 offset:768
  ds_write_b16 v22, v172 offset:896
  v_mov_b32 v20, 0xf149f2ca
  v_mov_b32 v21, 0
  v_mov_b32 v12, 0
  v_mov_b32 v13, 0
  v_mov_b32 v14, 0
  v_mov_b32 v15, 0
  v_mov_b32 v16, 0
  v_mov_b32 v17, 0
  v_mov_b32 v18, 0
  v_mov_b32 v19, 0
  s_waitcnt lgkmcnt(0)
  v_mov_b32 v22, 1
  v_mov_b32 v23, 1028
  ds_write_b32 v23, v22
  s_setprio 0
L_barB:
  s_lshr_b32 s67, s2, 3
  s_cmp_eq_u32 s95, 5
  s_cselect_b32 s67, s67, 255
  s_cmp_eq_u32 s46, 0
  s_cbranch_scc1 L_helper2
  v_bfe_u32 v22, v1, 3, 1
  v_lshlrev_b32 v22, 9, v22
  v_lshrrev_b32 v23, 4, v1
  v_lshl_add_u32 v22, v23, 4, v22
  ds_read_b128 v[32:35], v22 offset:0
  ds_read_b128 v[36:39], v22 offset:64
  ds_read_b128 v[40:43], v22 offset:128
  ds_read_b128 v[44:47], v22 offset:192
  ds_read_b128 v[48:51], v22 offset:256
  ds_read_b128 v[52:55], v22 offset:320
  ds_read_b128 v[56:59], v22 offset:384
  ds_read_b128 v[60:63], v22 offset:448
  s_waitcnt lgkmcnt(0)
  s_waitcnt vmcnt(63)
  v_mfma_f32_16x16x32_bf16 v[8:11], a[0:3], v[32:35], 0
  v_mfma_f32_16x16x32_bf16 v[8:11], a[4:7], v[36:39], v[8:11]
  v_mfma_f32_16x16x32_bf16 v[8:11], a[8:11], v[40:43], v[8:11]
  v_mfma_f32_16x16x32_bf16 v[8:11], a[12:15], v[44:47], v[8:11]
  v_mfma_f32_16x16x32_bf16 v[8:11], a[16:19], v[48:51], v[8:11]
  v_mfma_f32_16x16x32_bf16 v[8:11], a[20:23], v[52:55], v[8:11]
  v_mfma_f32_16x16x32_bf16 v[8:11], a[24:27], v[56:59], v[8:11]
  v_mfma_f32_16x16x32_bf16 v[8:11], a[28:31], v[60:63], v[8:11]
  s_nop 7
  v_cvt_pk_bf16_f32 v22, v8, v9
  v_cvt_pk_bf16_f32 v23, v10, v11
  v_lshlrev_b32 v8, 16, v22
  v_and_b32 v9, 0xffff0000, v22
  v_lshlrev_b32 v10, 16, v23
  v_and_b32 v11, 0xffff0000, v23
  v_max3_f32 v22, v8, v9, v10
  v_max_f32 v22, v22, v11
  v_mov_b32 v23, v22
  s_nop 1
  v_permlane16_swap_b32 v22, v23
  s_nop 1
  v_max_f32 v22, v22, v23
  v_mov_b32 v23, v22
  s_nop 1
  v_permlane32_swap_b32 v22, v23
  s_nop 1
  v_max_f32 v22, v22, v23
  v_mul_f32 v22, s94, v22
  v_max_f32 v22, v22, v20
  v_sub_f32 v23, v20, v22
  v_exp_f32 v23, v23
  v_mov_b32 v20, v22
  v_fma_f32 v8, v8, s94, -v22
  v_fma_f32 v9, v9, s94, -v22
  v_fma_f32 v10, v10, s94, -v22
  v_fma_f32 v11, v11, s94, -v22
  v_exp_f32 v8, v8
  v_exp_f32 v9, v9
  v_exp_f32 v10, v10
  v_exp_f32 v11, v11
  v_mul_f32 v12, v12, v23
  v_mul_f32 v13, v13, v23
  v_mul_f32 v14, v14, v23
  v_mul_f32 v15, v15, v23
  v_mul_f32 v16, v16, v23
  v_mul_f32 v17, v17, v23
  v_mul_f32 v18, v18, v23
  v_mul_f32 v19, v19, v23
  v_add_f32 v24, v8, v9
  v_add_f32 v25, v10, v11
  v_add_f32 v24, v24, v25
  v_fma_f32 v21, v21, v23, v24
  v_cvt_pk_bf16_f32 v24, v8, v8
  v_cvt_pk_bf16_f32 v25, v9, v9
  v_cvt_pk_bf16_f32 v26, v10, v10
  v_cvt_pk_bf16_f32 v27, v11, v11
  v_and_b32 v64, v24, v4
  v_and_b32 v65, v24, v5
  v_and_b32 v66, v24, v6
  v_and_b32 v67, v24, v7
  v_and_b32 v68, v25, v4
  v_and_b32 v69, v25, v5
  v_and_b32 v70, v25, v6
  v_and_b32 v71, v25, v7
  v_and_b32 v72, v26, v4
  v_and_b32 v73, v26, v5
  v_and_b32 v74, v26, v6
  v_and_b32 v75, v26, v7
  v_and_b32 v76, v27, v4
  v_and_b32 v77, v27, v5
  v_and_b32 v78, v27, v6
  v_and_b32 v79, v27, v7
  s_waitcnt vmcnt(63)
  s_nop 1
  v_mfma_f32_16x16x32_bf16 v[12:15], a[32:35], v[64:67], v[12:15]
  v_mfma_f32_16x16x32_bf16 v[16:19], a[36:39], v[64:67], v[16:19]
  v_mfma_f32_16x16x32_bf16 v[12:15], a[40:43], v[68:71], v[12:15]
  v_mfma_f32_16x16x32_bf16 v[16:19], a[44:47], v[68:71], v[16:19]
  v_mfma_f32_16x16x32_bf16 v[12:15], a[48:51], v[72:75], v[12:15]
  v_mfma_f32_16x16x32_bf16 v[16:19], a[52:55], v[72:75], v[16:19]
  v_mfma_f32_16x16x32_bf16 v[12:15], a[56:59], v[76:79], v[12:15]
  v_mfma_f32_16x16x32_bf16 v[16:19], a[60:63], v[76:79], v[16:19]
  s_add_u32 s62, s92, 1179648
  buffer_load_dwordx4 a[0:3], v3, s[32:35], s62 offen offset:0 nt
  buffer_load_dwordx4 a[4:7], v3, s[32:35], s62 offen offset:256 nt
  buffer_load_dwordx4 a[8:11], v3, s[32:35], s62 offen offset:512 nt
  buffer_load_dwordx4 a[12:15], v3, s[32:35], s62 offen offset:768 nt
  buffer_load_dwordx4 a[16:19], v3, s[32:35], s62 offen offset:1024 nt
  buffer_load_dwordx4 a[20:23], v3, s[32:35], s62 offen offset:1280 nt
  buffer_load_dwordx4 a[24:27], v3, s[32:35], s62 offen offset:1536 nt
  buffer_load_dwordx4 a[28:31], v3, s[32:35], s62 offen offset:1792 nt
  s_waitcnt vmcnt(63)
  v_mfma_f32_16x16x32_bf16 v[8:11], a[64:67], v[32:35], 0
  v_mfma_f32_16x16x32_bf16 v[8:11], a[68:71], v[36:39], v[8:11]
  v_mfma_f32_16x16x32_bf16 v[8:11], a[72:75], v[40:43], v[8:11]
  v_mfma_f32_16x16x32_bf16 v[8:11], a[76:79], v[44:47], v[8:11]
  v_mfma_f32_16x16x32_bf16 v[8:11], a[80:83], v[48:51], v[8:11]
  v_mfma_f32_16x16x32_bf16 v[8:11], a[84:87], v[52:55], v[8:11]
  v_mfma_f32_16x16x32_bf16 v[8:11], a[88:91], v[56:59], v[8:11]
  v_mfma_f32_16x16x32_bf16 v[8:11], a[92:95], v[60:63], v[8:11]
  s_nop 7
  v_cvt_pk_bf16_f32 v22, v8, v9
  v_cvt_pk_bf16_f32 v23, v10, v11
  v_lshlrev_b32 v8, 16, v22
  v_and_b32 v9, 0xffff0000, v22
  v_lshlrev_b32 v10, 16, v23
  v_and_b32 v11, 0xffff0000, v23
  v_max3_f32 v22, v8, v9, v10
  v_max_f32 v22, v22, v11
  v_mov_b32 v23, v22
  s_nop 1
  v_permlane16_swap_b32 v22, v23
  s_nop 1
  v_max_f32 v22, v22, v23
  v_mov_b32 v23, v22
  s_nop 1
  v_permlane32_swap_b32 v22, v23
  s_nop 1
  v_max_f32 v22, v22, v23
  v_mul_f32 v22, s94, v22
  v_max_f32 v22, v22, v20
  v_sub_f32 v23, v20, v22
  v_exp_f32 v23, v23
  v_mov_b32 v20, v22
  v_fma_f32 v8, v8, s94, -v22
  v_fma_f32 v9, v9, s94, -v22
  v_fma_f32 v10, v10, s94, -v22
  v_fma_f32 v11, v11, s94, -v22
  v_exp_f32 v8, v8
  v_exp_f32 v9, v9
  v_exp_f32 v10, v10
  v_exp_f32 v11, v11
  v_mul_f32 v12, v12, v23
  v_mul_f32 v13, v13, v23
  v_mul_f32 v14, v14, v23
  v_mul_f32 v15, v15, v23
  v_mul_f32 v16, v16, v23
  v_mul_f32 v17, v17, v23
  v_mul_f32 v18, v18, v23
  v_mul_f32 v19, v19, v23
  v_add_f32 v24, v8, v9
  v_add_f32 v25, v10, v11
  v_add_f32 v24, v24, v25
  v_fma_f32 v21, v21, v23, v24
  v_cvt_pk_bf16_f32 v24, v8, v8
  v_cvt_pk_bf16_f32 v25, v9, v9
  v_cvt_pk_bf16_f32 v26, v10, v10
  v_cvt_pk_bf16_f32 v27, v11, v11
  v_and_b32 v64, v24, v4
  v_and_b32 v65, v24, v5
  v_and_b32 v66, v24, v6
  v_and_b32 v67, v24, v7
  v_and_b32 v68, v25, v4
  v_and_b32 v69, v25, v5
  v_and_b32 v70, v25, v6
  v_and_b32 v71, v25, v7
  v_and_b32 v72, v26, v4
  v_and_b32 v73, v26, v5
  v_and_b32 v74, v26, v6
  v_and_b32 v75, v26, v7
  v_and_b32 v76, v27, v4
  v_and_b32 v77, v27, v5
  v_and_b32 v78, v27, v6
  v_and_b32 v79, v27, v7
  s_waitcnt vmcnt(63)
  s_nop 1
  v_mfma_f32_16x16x32_bf16 v[12:15], a[96:99], v[64:67], v[12:15]
  v_mfma_f32_16x16x32_bf16 v[16:19], a[100:103], v[64:67], v[16:19]
  v_mfma_f32_16x16x32_bf16 v[12:15], a[104:107], v[68:71], v[12:15]
  v_mfma_f32_16x16x32_bf16 v[16:19], a[108:111], v[68:71], v[16:19]
  v_mfma_f32_16x16x32_bf16 v[12:15], a[112:115], v[72:75], v[12:15]
  v_mfma_f32_16x16x32_bf16 v[16:19], a[116:119], v[72:75], v[16:19]
  v_mfma_f32_16x16x32_bf16 v[12:15], a[120:123], v[76:79], v[12:15]
  v_mfma_f32_16x16x32_bf16 v[16:19], a[124:127], v[76:79], v[16:19]
  s_add_u32 s63, s93, 0
  buffer_load_dwordx4 a[32:35], v2, s[28:31], s63 offen offset:0 nt
  buffer_load_dwordx4 a[36:39], v2, s[28:31], s63 offen offset:64 nt
  buffer_load_dwordx4 a[40:43], v2, s[28:31], s63 offen offset:128 nt
  buffer_load_dwordx4 a[44:47], v2, s[28:31], s63 offen offset:192 nt
  buffer_load_dwordx4 a[48:51], v2, s[28:31], s63 offen offset:256 nt
  buffer_load_dwordx4 a[52:55], v2, s[28:31], s63 offen offset:320 nt
  buffer_load_dwordx4 a[56:59], v2, s[28:31], s63 offen offset:384 nt
  buffer_load_dwordx4 a[60:63], v2, s[28:31], s63 offen offset:448 nt
  s_waitcnt vmcnt(63)
  v_mfma_f32_16x16x32_bf16 v[8:11], a[128:131], v[32:35], 0
  v_mfma_f32_16x16x32_bf16 v[8:11], a[132:135], v[36:39], v[8:11]
  v_mfma_f32_16x16x32_bf16 v[8:11], a[136:139], v[40:43], v[8:11]
  v_mfma_f32_16x16x32_bf16 v[8:11], a[140:143], v[44:47], v[8:11]
  v_mfma_f32_16x16x32_bf16 v[8:11], a[144:147], v[48:51], v[8:11]
  v_mfma_f32_16x16x32_bf16 v[8:11], a[148:151], v[52:55], v[8:11]
  v_mfma_f32_16x16x32_bf16 v[8:11], a[152:155], v[56:59], v[8:11]
  v_mfma_f32_16x16x32_bf16 v[8:11], a[156:159], v[60:63], v[8:11]
  s_nop 7
  v_cvt_pk_bf16_f32 v22, v8, v9
  v_cvt_pk_bf16_f32 v23, v10, v11
  v_lshlrev_b32 v8, 16, v22
  v_and_b32 v9, 0xffff0000, v22
  v_lshlrev_b32 v10, 16, v23
  v_and_b32 v11, 0xffff0000, v23
  v_max3_f32 v22, v8, v9, v10
  v_max_f32 v22, v22, v11
  v_mov_b32 v23, v22
  s_nop 1
  v_permlane16_swap_b32 v22, v23
  s_nop 1
  v_max_f32 v22, v22, v23
  v_mov_b32 v23, v22
  s_nop 1
  v_permlane32_swap_b32 v22, v23
  s_nop 1
  v_max_f32 v22, v22, v23
  v_mul_f32 v22, s94, v22
  v_max_f32 v22, v22, v20
  v_sub_f32 v23, v20, v22
  v_exp_f32 v23, v23
  v_mov_b32 v20, v22
  v_fma_f32 v8, v8, s94, -v22
  v_fma_f32 v9, v9, s94, -v22
  v_fma_f32 v10, v10, s94, -v22
  v_fma_f32 v11, v11, s94, -v22
  v_exp_f32 v8, v8
  v_exp_f32 v9, v9
  v_exp_f32 v10, v10
  v_exp_f32 v11, v11
  v_mul_f32 v12, v12, v23
  v_mul_f32 v13, v13, v23
  v_mul_f32 v14, v14, v23
  v_mul_f32 v15, v15, v23
  v_mul_f32 v16, v16, v23
  v_mul_f32 v17, v17, v23
  v_mul_f32 v18, v18, v23
  v_mul_f32 v19, v19, v23
  v_add_f32 v24, v8, v9
  v_add_f32 v25, v10, v11
  v_add_f32 v24, v24, v25
  v_fma_f32 v21, v21, v23, v24
  v_cvt_pk_bf16_f32 v24, v8, v8
  v_cvt_pk_bf16_f32 v25, v9, v9
  v_cvt_pk_bf16_f32 v26, v10, v10
  v_cvt_pk_bf16_f32 v27, v11, v11
  v_and_b32 v64, v24, v4
  v_and_b32 v65, v24, v5
  v_and_b32 v66, v24, v6
  v_and_b32 v67, v24, v7
  v_and_b32 v68, v25, v4
  v_and_b32 v69, v25, v5
  v_and_b32 v70, v25, v6
  v_and_b32 v71, v25, v7
  v_and_b32 v72, v26, v4
  v_and_b32 v73, v26, v5
  v_and_b32 v74, v26, v6
  v_and_b32 v75, v26, v7
  v_and_b32 v76, v27, v4
  v_and_b32 v77, v27, v5
  v_and_b32 v78, v27, v6
  v_and_b32 v79, v27, v7
  s_waitcnt vmcnt(63)
  s_nop 1
  v_mfma_f32_16x16x32_bf16 v[12:15], a[160:163], v[64:67], v[12:15]
  v_mfma_f32_16x16x32_bf16 v[16:19], a[164:167], v[64:67], v[16:19]
  v_mfma_f32_16x16x32_bf16 v[12:15], a[168:171], v[68:71], v[12:15]
  v_mfma_f32_16x16x32_bf16 v[16:19], a[172:175], v[68:71], v[16:19]
  v_mfma_f32_16x16x32_bf16 v[12:15], a[176:179], v[72:75], v[12:15]
  v_mfma_f32_16x16x32_bf16 v[16:19], a[180:183], v[72:75], v[16:19]
  v_mfma_f32_16x16x32_bf16 v[12:15], a[184:187], v[76:79], v[12:15]
  v_mfma_f32_16x16x32_bf16 v[16:19], a[188:191], v[76:79], v[16:19]
  buffer_load_dwordx4 a[64:67], v3, s[32:35], s63 offen offset:0 nt
  buffer_load_dwordx4 a[68:71], v3, s[32:35], s63 offen offset:256 nt
  buffer_load_dwordx4 a[72:75], v3, s[32:35], s63 offen offset:512 nt
  buffer_load_dwordx4 a[76:79], v3, s[32:35], s63 offen offset:768 nt
  buffer_load_dwordx4 a[80:83], v3, s[32:35], s63 offen offset:1024 nt
  buffer_load_dwordx4 a[84:87], v3, s[32:35], s63 offen offset:1280 nt
  buffer_load_dwordx4 a[88:91], v3, s[32:35], s63 offen offset:1536 nt
  buffer_load_dwordx4 a[92:95], v3, s[32:35], s63 offen offset:1792 nt
  s_waitcnt vmcnt(63)
  v_mfma_f32_16x16x32_bf16 v[8:11], a[192:195], v[32:35], 0
  v_mfma_f32_16x16x32_bf16 v[8:11], a[196:199], v[36:39], v[8:11]
  v_mfma_f32_16x16x32_bf16 v[8:11], a[200:203], v[40:43], v[8:11]
  v_mfma_f32_16x16x32_bf16 v[8:11], a[204:207], v[44:47], v[8:11]
  v_mfma_f32_16x16x32_bf16 v[8:11], a[208:211], v[48:51], v[8:11]
  v_mfma_f32_16x16x32_bf16 v[8:11], a[212:215], v[52:55], v[8:11]
  v_mfma_f32_16x16x32_bf16 v[8:11], a[216:219], v[56:59], v[8:11]
  v_mfma_f32_16x16x32_bf16 v[8:11], a[220:223], v[60:63], v[8:11]
  s_nop 7
  v_cvt_pk_bf16_f32 v22, v8, v9
  v_cvt_pk_bf16_f32 v23, v10, v11
  v_lshlrev_b32 v8, 16, v22
  v_and_b32 v9, 0xffff0000, v22
  v_lshlrev_b32 v10, 16, v23
  v_and_b32 v11, 0xffff0000, v23
  v_max3_f32 v22, v8, v9, v10
  v_max_f32 v22, v22, v11
  v_mov_b32 v23, v22
  s_nop 1
  v_permlane16_swap_b32 v22, v23
  s_nop 1
  v_max_f32 v22, v22, v23
  v_mov_b32 v23, v22
  s_nop 1
  v_permlane32_swap_b32 v22, v23
  s_nop 1
  v_max_f32 v22, v22, v23
  v_mul_f32 v22, s94, v22
  v_max_f32 v22, v22, v20
  v_sub_f32 v23, v20, v22
  v_exp_f32 v23, v23
  v_mov_b32 v20, v22
  v_fma_f32 v8, v8, s94, -v22
  v_fma_f32 v9, v9, s94, -v22
  v_fma_f32 v10, v10, s94, -v22
  v_fma_f32 v11, v11, s94, -v22
  v_exp_f32 v8, v8
  v_exp_f32 v9, v9
  v_exp_f32 v10, v10
  v_exp_f32 v11, v11
  v_mul_f32 v12, v12, v23
  v_mul_f32 v13, v13, v23
  v_mul_f32 v14, v14, v23
  v_mul_f32 v15, v15, v23
  v_mul_f32 v16, v16, v23
  v_mul_f32 v17, v17, v23
  v_mul_f32 v18, v18, v23
  v_mul_f32 v19, v19, v23
  v_add_f32 v24, v8, v9
  v_add_f32 v25, v10, v11
  v_add_f32 v24, v24, v25
  v_fma_f32 v21, v21, v23, v24
  v_cvt_pk_bf16_f32 v24, v8, v8
  v_cvt_pk_bf16_f32 v25, v9, v9
  v_cvt_pk_bf16_f32 v26, v10, v10
  v_cvt_pk_bf16_f32 v27, v11, v11
  v_and_b32 v64, v24, v4
  v_and_b32 v65, v24, v5
  v_and_b32 v66, v24, v6
  v_and_b32 v67, v24, v7
  v_and_b32 v68, v25, v4
  v_and_b32 v69, v25, v5
  v_and_b32 v70, v25, v6
  v_and_b32 v71, v25, v7
  v_and_b32 v72, v26, v4
  v_and_b32 v73, v26, v5
  v_and_b32 v74, v26, v6
  v_and_b32 v75, v26, v7
  v_and_b32 v76, v27, v4
  v_and_b32 v77, v27, v5
  v_and_b32 v78, v27, v6
  v_and_b32 v79, v27, v7
  s_waitcnt vmcnt(63)
  s_nop 1
  v_mfma_f32_16x16x32_bf16 v[12:15], a[224:227], v[64:67], v[12:15]
  v_mfma_f32_16x16x32_bf16 v[16:19], a[228:231], v[64:67], v[16:19]
  v_mfma_f32_16x16x32_bf16 v[12:15], a[232:235], v[68:71], v[12:15]
  v_mfma_f32_16x16x32_bf16 v[16:19], a[236:239], v[68:71], v[16:19]
  v_mfma_f32_16x16x32_bf16 v[12:15], a[240:243], v[72:75], v[12:15]
  v_mfma_f32_16x16x32_bf16 v[16:19], a[244:247], v[72:75], v[16:19]
  v_mfma_f32_16x16x32_bf16 v[12:15], a[248:251], v[76:79], v[12:15]
  v_mfma_f32_16x16x32_bf16 v[16:19], a[252:255], v[76:79], v[16:19]
  s_add_u32 s56, s93, 131072
  buffer_load_dwordx4 a[96:99], v2, s[28:31], s56 offen offset:0 nt
  buffer_load_dwordx4 a[100:103], v2, s[28:31], s56 offen offset:64 nt
  buffer_load_dwordx4 a[104:107], v2, s[28:31], s56 offen offset:128 nt
  buffer_load_dwordx4 a[108:111], v2, s[28:31], s56 offen offset:192 nt
  buffer_load_dwordx4 a[112:115], v2, s[28:31], s56 offen offset:256 nt
  buffer_load_dwordx4 a[116:119], v2, s[28:31], s56 offen offset:320 nt
  buffer_load_dwordx4 a[120:123], v2, s[28:31], s56 offen offset:384 nt
  buffer_load_dwordx4 a[124:127], v2, s[28:31], s56 offen offset:448 nt
  s_waitcnt vmcnt(63)
  v_mfma_f32_16x16x32_bf16 v[8:11], v[96:99], v[32:35], 0
  v_mfma_f32_16x16x32_bf16 v[8:11], v[100:103], v[36:39], v[8:11]
  v_mfma_f32_16x16x32_bf16 v[8:11], v[104:107], v[40:43], v[8:11]
  v_mfma_f32_16x16x32_bf16 v[8:11], v[108:111], v[44:47], v[8:11]
  v_mfma_f32_16x16x32_bf16 v[8:11], v[112:115], v[48:51], v[8:11]
  v_mfma_f32_16x16x32_bf16 v[8:11], v[116:119], v[52:55], v[8:11]
  v_mfma_f32_16x16x32_bf16 v[8:11], v[120:123], v[56:59], v[8:11]
  v_mfma_f32_16x16x32_bf16 v[8:11], v[124:127], v[60:63], v[8:11]
  s_nop 7
  v_cvt_pk_bf16_f32 v22, v8, v9
  v_cvt_pk_bf16_f32 v23, v10, v11
  v_lshlrev_b32 v8, 16, v22
  v_and_b32 v9, 0xffff0000, v22
  v_lshlrev_b32 v10, 16, v23
  v_and_b32 v11, 0xffff0000, v23
  v_max3_f32 v22, v8, v9, v10
  v_max_f32 v22, v22, v11
  v_mov_b32 v23, v22
  s_nop 1
  v_permlane16_swap_b32 v22, v23
  s_nop 1
  v_max_f32 v22, v22, v23
  v_mov_b32 v23, v22
  s_nop 1
  v_permlane32_swap_b32 v22, v23
  s_nop 1
  v_max_f32 v22, v22, v23
  v_mul_f32 v22, s94, v22
  v_max_f32 v22, v22, v20
  v_sub_f32 v23, v20, v22
  v_exp_f32 v23, v23
  v_mov_b32 v20, v22
  v_fma_f32 v8, v8, s94, -v22
  v_fma_f32 v9, v9, s94, -v22
  v_fma_f32 v10, v10, s94, -v22
  v_fma_f32 v11, v11, s94, -v22
  v_exp_f32 v8, v8
  v_exp_f32 v9, v9
  v_exp_f32 v10, v10
  v_exp_f32 v11, v11
  v_mul_f32 v12, v12, v23
  v_mul_f32 v13, v13, v23
  v_mul_f32 v14, v14, v23
  v_mul_f32 v15, v15, v23
  v_mul_f32 v16, v16, v23
  v_mul_f32 v17, v17, v23
  v_mul_f32 v18, v18, v23
  v_mul_f32 v19, v19, v23
  v_add_f32 v24, v8, v9
  v_add_f32 v25, v10, v11
  v_add_f32 v24, v24, v25
  v_fma_f32 v21, v21, v23, v24
  v_cvt_pk_bf16_f32 v24, v8, v8
  v_cvt_pk_bf16_f32 v25, v9, v9
  v_cvt_pk_bf16_f32 v26, v10, v10
  v_cvt_pk_bf16_f32 v27, v11, v11
  v_and_b32 v64, v24, v4
  v_and_b32 v65, v24, v5
  v_and_b32 v66, v24, v6
  v_and_b32 v67, v24, v7
  v_and_b32 v68, v25, v4
  v_and_b32 v69, v25, v5
  v_and_b32 v70, v25, v6
  v_and_b32 v71, v25, v7
  v_and_b32 v72, v26, v4
  v_and_b32 v73, v26, v5
  v_and_b32 v74, v26, v6
  v_and_b32 v75, v26, v7
  v_and_b32 v76, v27, v4
  v_and_b32 v77, v27, v5
  v_and_b32 v78, v27, v6
  v_and_b32 v79, v27, v7
  s_waitcnt vmcnt(56)
  s_nop 1
  v_mfma_f32_16x16x32_bf16 v[12:15], v[128:131], v[64:67], v[12:15]
  v_mfma_f32_16x16x32_bf16 v[16:19], v[132:135], v[64:67], v[16:19]
  v_mfma_f32_16x16x32_bf16 v[12:15], v[136:139], v[68:71], v[12:15]
  v_mfma_f32_16x16x32_bf16 v[16:19], v[140:143], v[68:71], v[16:19]
  v_mfma_f32_16x16x32_bf16 v[12:15], v[144:147], v[72:75], v[12:15]
  v_mfma_f32_16x16x32_bf16 v[16:19], v[148:151], v[72:75], v[16:19]
  v_mfma_f32_16x16x32_bf16 v[12:15], v[152:155], v[76:79], v[12:15]
  v_mfma_f32_16x16x32_bf16 v[16:19], v[156:159], v[76:79], v[16:19]
  buffer_load_dwordx4 a[128:131], v3, s[32:35], s56 offen offset:0 nt
  buffer_load_dwordx4 a[132:135], v3, s[32:35], s56 offen offset:256 nt
  buffer_load_dwordx4 a[136:139], v3, s[32:35], s56 offen offset:512 nt
  buffer_load_dwordx4 a[140:143], v3, s[32:35], s56 offen offset:768 nt
  buffer_load_dwordx4 a[144:147], v3, s[32:35], s56 offen offset:1024 nt
  buffer_load_dwordx4 a[148:151], v3, s[32:35], s56 offen offset:1280 nt
  buffer_load_dwordx4 a[152:155], v3, s[32:35], s56 offen offset:1536 nt
  buffer_load_dwordx4 a[156:159], v3, s[32:35], s56 offen offset:1792 nt
  s_waitcnt vmcnt(56)
  v_mfma_f32_16x16x32_bf16 v[8:11], v[160:163], v[32:35], 0
  v_mfma_f32_16x16x32_bf16 v[8:11], v[164:167], v[36:39], v[8:11]
  v_mfma_f32_16x16x32_bf16 v[8:11], v[168:171], v[40:43], v[8:11]
  v_mfma_f32_16x16x32_bf16 v[8:11], v[172:175], v[44:47], v[8:11]
  v_mfma_f32_16x16x32_bf16 v[8:11], v[176:179], v[48:51], v[8:11]
  v_mfma_f32_16x16x32_bf16 v[8:11], v[180:183], v[52:55], v[8:11]
  v_mfma_f32_16x16x32_bf16 v[8:11], v[184:187], v[56:59], v[8:11]
  v_mfma_f32_16x16x32_bf16 v[8:11], v[188:191], v[60:63], v[8:11]
  s_nop 7
  v_cvt_pk_bf16_f32 v22, v8, v9
  v_cvt_pk_bf16_f32 v23, v10, v11
  v_lshlrev_b32 v8, 16, v22
  v_and_b32 v9, 0xffff0000, v22
  v_lshlrev_b32 v10, 16, v23
  v_and_b32 v11, 0xffff0000, v23
  v_max3_f32 v22, v8, v9, v10
  v_max_f32 v22, v22, v11
  v_mov_b32 v23, v22
  s_nop 1
  v_permlane16_swap_b32 v22, v23
  s_nop 1
  v_max_f32 v22, v22, v23
  v_mov_b32 v23, v22
  s_nop 1
  v_permlane32_swap_b32 v22, v23
  s_nop 1
  v_max_f32 v22, v22, v23
  v_mul_f32 v22, s94, v22
  v_max_f32 v22, v22, v20
  v_sub_f32 v23, v20, v22
  v_exp_f32 v23, v23
  v_mov_b32 v20, v22
  v_fma_f32 v8, v8, s94, -v22
  v_fma_f32 v9, v9, s94, -v22
  v_fma_f32 v10, v10, s94, -v22
  v_fma_f32 v11, v11, s94, -v22
  v_exp_f32 v8, v8
  v_exp_f32 v9, v9
  v_exp_f32 v10, v10
  v_exp_f32 v11, v11
  v_mul_f32 v12, v12, v23
  v_mul_f32 v13, v13, v23
  v_mul_f32 v14, v14, v23
  v_mul_f32 v15, v15, v23
  v_mul_f32 v16, v16, v23
  v_mul_f32 v17, v17, v23
  v_mul_f32 v18, v18, v23
  v_mul_f32 v19, v19, v23
  v_add_f32 v24, v8, v9
  v_add_f32 v25, v10, v11
  v_add_f32 v24, v24, v25
  v_fma_f32 v21, v21, v23, v24
  v_cvt_pk_bf16_f32 v24, v8, v8
  v_cvt_pk_bf16_f32 v25, v9, v9
  v_cvt_pk_bf16_f32 v26, v10, v10
  v_cvt_pk_bf16_f32 v27, v11, v11
  v_and_b32 v64, v24, v4
  v_and_b32 v65, v24, v5
  v_and_b32 v66, v24, v6
  v_and_b32 v67, v24, v7
  v_and_b32 v68, v25, v4
  v_and_b32 v69, v25, v5
  v_and_b32 v70, v25, v6
  v_and_b32 v71, v25, v7
  v_and_b32 v72, v26, v4
  v_and_b32 v73, v26, v5
  v_and_b32 v74, v26, v6
  v_and_b32 v75, v26, v7
  v_and_b32 v76, v27, v4
  v_and_b32 v77, v27, v5
  v_and_b32 v78, v27, v6
  v_and_b32 v79, v27, v7
  s_waitcnt vmcnt(48)
  s_nop 1
  v_mfma_f32_16x16x32_bf16 v[12:15], v[192:195], v[64:67], v[12:15]
  v_mfma_f32_16x16x32_bf16 v[16:19], v[196:199], v[64:67], v[16:19]
  v_mfma_f32_16x16x32_bf16 v[12:15], v[200:203], v[68:71], v[12:15]
  v_mfma_f32_16x16x32_bf16 v[16:19], v[204:207], v[68:71], v[16:19]
  v_mfma_f32_16x16x32_bf16 v[12:15], v[208:211], v[72:75], v[12:15]
  v_mfma_f32_16x16x32_bf16 v[16:19], v[212:215], v[72:75], v[16:19]
  v_mfma_f32_16x16x32_bf16 v[12:15], v[216:219], v[76:79], v[12:15]
  v_mfma_f32_16x16x32_bf16 v[16:19], v[220:223], v[76:79], v[16:19]
  s_add_u32 s57, s93, 262144
  buffer_load_dwordx4 a[160:163], v2, s[28:31], s57 offen offset:0 nt
  buffer_load_dwordx4 a[164:167], v2, s[28:31], s57 offen offset:64 nt
  buffer_load_dwordx4 a[168:171], v2, s[28:31], s57 offen offset:128 nt
  buffer_load_dwordx4 a[172:175], v2, s[28:31], s57 offen offset:192 nt
  buffer_load_dwordx4 a[176:179], v2, s[28:31], s57 offen offset:256 nt
  buffer_load_dwordx4 a[180:183], v2, s[28:31], s57 offen offset:320 nt
  buffer_load_dwordx4 a[184:187], v2, s[28:31], s57 offen offset:384 nt
  buffer_load_dwordx4 a[188:191], v2, s[28:31], s57 offen offset:448 nt
  s_waitcnt vmcnt(48)
  v_mfma_f32_16x16x32_bf16 v[8:11], v[224:227], v[32:35], 0
  v_mfma_f32_16x16x32_bf16 v[8:11], v[228:231], v[36:39], v[8:11]
  v_mfma_f32_16x16x32_bf16 v[8:11], v[232:235], v[40:43], v[8:11]
  v_mfma_f32_16x16x32_bf16 v[8:11], v[236:239], v[44:47], v[8:11]
  v_mfma_f32_16x16x32_bf16 v[8:11], v[240:243], v[48:51], v[8:11]
  v_mfma_f32_16x16x32_bf16 v[8:11], v[244:247], v[52:55], v[8:11]
  v_mfma_f32_16x16x32_bf16 v[8:11], v[248:251], v[56:59], v[8:11]
  v_mfma_f32_16x16x32_bf16 v[8:11], v[252:255], v[60:63], v[8:11]
  s_nop 7
  v_cvt_pk_bf16_f32 v22, v8, v9
  v_cvt_pk_bf16_f32 v23, v10, v11
  v_lshlrev_b32 v8, 16, v22
  v_and_b32 v9, 0xffff0000, v22
  v_lshlrev_b32 v10, 16, v23
  v_and_b32 v11, 0xffff0000, v23
  v_max3_f32 v22, v8, v9, v10
  v_max_f32 v22, v22, v11
  v_mov_b32 v23, v22
  s_nop 1
  v_permlane16_swap_b32 v22, v23
  s_nop 1
  v_max_f32 v22, v22, v23
  v_mov_b32 v23, v22
  s_nop 1
  v_permlane32_swap_b32 v22, v23
  s_nop 1
  v_max_f32 v22, v22, v23
  v_mul_f32 v22, s94, v22
  v_max_f32 v22, v22, v20
  v_sub_f32 v23, v20, v22
  v_exp_f32 v23, v23
  v_mov_b32 v20, v22
  v_fma_f32 v8, v8, s94, -v22
  v_fma_f32 v9, v9, s94, -v22
  v_fma_f32 v10, v10, s94, -v22
  v_fma_f32 v11, v11, s94, -v22
  v_exp_f32 v8, v8
  v_exp_f32 v9, v9
  v_exp_f32 v10, v10
  v_exp_f32 v11, v11
  v_mul_f32 v12, v12, v23
  v_mul_f32 v13, v13, v23
  v_mul_f32 v14, v14, v23
  v_mul_f32 v15, v15, v23
  v_mul_f32 v16, v16, v23
  v_mul_f32 v17, v17, v23
  v_mul_f32 v18, v18, v23
  v_mul_f32 v19, v19, v23
  v_add_f32 v24, v8, v9
  v_add_f32 v25, v10, v11
  v_add_f32 v24, v24, v25
  v_fma_f32 v21, v21, v23, v24
  v_cvt_pk_bf16_f32 v24, v8, v8
  v_cvt_pk_bf16_f32 v25, v9, v9
  v_cvt_pk_bf16_f32 v26, v10, v10
  v_cvt_pk_bf16_f32 v27, v11, v11
  v_and_b32 v64, v24, v4
  v_and_b32 v65, v24, v5
  v_and_b32 v66, v24, v6
  v_and_b32 v67, v24, v7
  v_and_b32 v68, v25, v4
  v_and_b32 v69, v25, v5
  v_and_b32 v70, v25, v6
  v_and_b32 v71, v25, v7
  v_and_b32 v72, v26, v4
  v_and_b32 v73, v26, v5
  v_and_b32 v74, v26, v6
  v_and_b32 v75, v26, v7
  v_and_b32 v76, v27, v4
  v_and_b32 v77, v27, v5
  v_and_b32 v78, v27, v6
  v_and_b32 v79, v27, v7
  s_waitcnt vmcnt(40)
  s_nop 1
  v_mfma_f32_16x16x32_bf16 v[12:15], a[0:3], v[64:67], v[12:15]
  v_mfma_f32_16x16x32_bf16 v[16:19], a[4:7], v[64:67], v[16:19]
  v_mfma_f32_16x16x32_bf16 v[12:15], a[8:11], v[68:71], v[12:15]
  v_mfma_f32_16x16x32_bf16 v[16:19], a[12:15], v[68:71], v[16:19]
  v_mfma_f32_16x16x32_bf16 v[12:15], a[16:19], v[72:75], v[12:15]
  v_mfma_f32_16x16x32_bf16 v[16:19], a[20:23], v[72:75], v[16:19]
  v_mfma_f32_16x16x32_bf16 v[12:15], a[24:27], v[76:79], v[12:15]
  v_mfma_f32_16x16x32_bf16 v[16:19], a[28:31], v[76:79], v[16:19]
  buffer_load_dwordx4 a[192:195], v3, s[32:35], s57 offen offset:0 nt
  buffer_load_dwordx4 a[196:199], v3, s[32:35], s57 offen offset:256 nt
  buffer_load_dwordx4 a[200:203], v3, s[32:35], s57 offen offset:512 nt
  buffer_load_dwordx4 a[204:207], v3, s[32:35], s57 offen offset:768 nt
  buffer_load_dwordx4 a[208:211], v3, s[32:35], s57 offen offset:1024 nt
  buffer_load_dwordx4 a[212:215], v3, s[32:35], s57 offen offset:1280 nt
  buffer_load_dwordx4 a[216:219], v3, s[32:35], s57 offen offset:1536 nt
  buffer_load_dwordx4 a[220:223], v3, s[32:35], s57 offen offset:1792 nt
  s_cmp_ge_u32 s63, 8388608
  s_cbranch_scc1 L_loopend
  s_waitcnt vmcnt(40)
  v_mfma_f32_16x16x32_bf16 v[8:11], a[32:35], v[32:35], 0
  v_mfma_f32_16x16x32_bf16 v[8:11], a[36:39], v[36:39], v[8:11]
  v_mfma_f32_16x16x32_bf16 v[8:11], a[40:43], v[40:43], v[8:11]
  v_mfma_f32_16x16x32_bf16 v[8:11], a[44:47], v[44:47], v[8:11]
  v_mfma_f32_16x16x32_bf16 v[8:11], a[48:51], v[48:51], v[8:11]
  v_mfma_f32_16x16x32_bf16 v[8:11], a[52:55], v[52:55], v[8:11]
  v_mfma_f32_16x16x32_bf16 v[8:11], a[56:59], v[56:59], v[8:11]
  v_mfma_f32_16x16x32_bf16 v[8:11], a[60:63], v[60:63], v[8:11]
  s_nop 7
  v_cvt_pk_bf16_f32 v22, v8, v9
  v_cvt_pk_bf16_f32 v23, v10, v11
  v_lshlrev_b32 v8, 16, v22
  v_and_b32 v9, 0xffff0000, v22
  v_lshlrev_b32 v10, 16, v23
  v_and_b32 v11, 0xffff0000, v23
  v_max3_f32 v22, v8, v9, v10
  v_max_f32 v22, v22, v11
  v_mov_b32 v23, v22
  s_nop 1
  v_permlane16_swap_b32 v22, v23
  s_nop 1
  v_max_f32 v22, v22, v23
  v_mov_b32 v23, v22
  s_nop 1
  v_permlane32_swap_b32 v22, v23
  s_nop 1
  v_max_f32 v22, v22, v23
  v_mul_f32 v22, s94, v22
  v_max_f32 v22, v22, v20
  v_sub_f32 v23, v20, v22
  v_exp_f32 v23, v23
  v_mov_b32 v20, v22
  v_fma_f32 v8, v8, s94, -v22
  v_fma_f32 v9, v9, s94, -v22
  v_fma_f32 v10, v10, s94, -v22
  v_fma_f32 v11, v11, s94, -v22
  v_exp_f32 v8, v8
  v_exp_f32 v9, v9
  v_exp_f32 v10, v10
  v_exp_f32 v11, v11
  v_mul_f32 v12, v12, v23
  v_mul_f32 v13, v13, v23
  v_mul_f32 v14, v14, v23
  v_mul_f32 v15, v15, v23
  v_mul_f32 v16, v16, v23
  v_mul_f32 v17, v17, v23
  v_mul_f32 v18, v18, v23
  v_mul_f32 v19, v19, v23
  v_add_f32 v24, v8, v9
  v_add_f32 v25, v10, v11
  v_add_f32 v24, v24, v25
  v_fma_f32 v21, v21, v23, v24
  v_cvt_pk_bf16_f32 v24, v8, v8
  v_cvt_pk_bf16_f32 v25, v9, v9
  v_cvt_pk_bf16_f32 v26, v10, v10
  v_cvt_pk_bf16_f32 v27, v11, v11
  v_and_b32 v64, v24, v4
  v_and_b32 v65, v24, v5
  v_and_b32 v66, v24, v6
  v_and_b32 v67, v24, v7
  v_and_b32 v68, v25, v4
  v_and_b32 v69, v25, v5
  v_and_b32 v70, v25, v6
  v_and_b32 v71, v25, v7
  v_and_b32 v72, v26, v4
  v_and_b32 v73, v26, v5
  v_and_b32 v74, v26, v6
  v_and_b32 v75, v26, v7
  v_and_b32 v76, v27, v4
  v_and_b32 v77, v27, v5
  v_and_b32 v78, v27, v6
  v_and_b32 v79, v27, v7
  s_waitcnt vmcnt(32)
  s_nop 1
  v_mfma_f32_16x16x32_bf16 v[12:15], a[64:67], v[64:67], v[12:15]
  v_mfma_f32_16x16x32_bf16 v[16:19], a[68:71], v[64:67], v[16:19]
  v_mfma_f32_16x16x32_bf16 v[12:15], a[72:75], v[68:71], v[12:15]
  v_mfma_f32_16x16x32_bf16 v[16:19], a[76:79], v[68:71], v[16:19]
  v_mfma_f32_16x16x32_bf16 v[12:15], a[80:83], v[72:75], v[12:15]
  v_mfma_f32_16x16x32_bf16 v[16:19], a[84:87], v[72:75], v[16:19]
  v_mfma_f32_16x16x32_bf16 v[12:15], a[88:91], v[76:79], v[12:15]
  v_mfma_f32_16x16x32_bf16 v[16:19], a[92:95], v[76:79], v[16:19]
  s_add_u32 s58, s93, 393216
  buffer_load_dwordx4 a[224:227], v2, s[28:31], s58 offen offset:0 nt
  buffer_load_dwordx4 a[228:231], v2, s[28:31], s58 offen offset:64 nt
  buffer_load_dwordx4 a[232:235], v2, s[28:31], s58 offen offset:128 nt
  buffer_load_dwordx4 a[236:239], v2, s[28:31], s58 offen offset:192 nt
  buffer_load_dwordx4 a[240:243], v2, s[28:31], s58 offen offset:256 nt
  buffer_load_dwordx4 a[244:247], v2, s[28:31], s58 offen offset:320 nt
  buffer_load_dwordx4 a[248:251], v2, s[28:31], s58 offen offset:384 nt
  buffer_load_dwordx4 a[252:255], v2, s[28:31], s58 offen offset:448 nt
  s_cmp_ge_u32 s56, 8388608
  s_cbranch_scc1 L_loopend
  s_waitcnt vmcnt(32)
  v_mfma_f32_16x16x32_bf16 v[8:11], a[96:99], v[32:35], 0
  v_mfma_f32_16x16x32_bf16 v[8:11], a[100:103], v[36:39], v[8:11]
  v_mfma_f32_16x16x32_bf16 v[8:11], a[104:107], v[40:43], v[8:11]
  v_mfma_f32_16x16x32_bf16 v[8:11], a[108:111], v[44:47], v[8:11]
  v_mfma_f32_16x16x32_bf16 v[8:11], a[112:115], v[48:51], v[8:11]
  v_mfma_f32_16x16x32_bf16 v[8:11], a[116:119], v[52:55], v[8:11]
  v_mfma_f32_16x16x32_bf16 v[8:11], a[120:123], v[56:59], v[8:11]
  v_mfma_f32_16x16x32_bf16 v[8:11], a[124:127], v[60:63], v[8:11]
  s_nop 7
  v_cvt_pk_bf16_f32 v22, v8, v9
  v_cvt_pk_bf16_f32 v23, v10, v11
  v_lshlrev_b32 v8, 16, v22
  v_and_b32 v9, 0xffff0000, v22
  v_lshlrev_b32 v10, 16, v23
  v_and_b32 v11, 0xffff0000, v23
  v_max3_f32 v22, v8, v9, v10
  v_max_f32 v22, v22, v11
  v_mov_b32 v23, v22
  s_nop 1
  v_permlane16_swap_b32 v22, v23
  s_nop 1
  v_max_f32 v22, v22, v23
  v_mov_b32 v23, v22
  s_nop 1
  v_permlane32_swap_b32 v22, v23
  s_nop 1
  v_max_f32 v22, v22, v23
  v_mul_f32 v22, s94, v22
  v_max_f32 v22, v22, v20
  v_sub_f32 v23, v20, v22
  v_exp_f32 v23, v23
  v_mov_b32 v20, v22
  v_fma_f32 v8, v8, s94, -v22
  v_fma_f32 v9, v9, s94, -v22
  v_fma_f32 v10, v10, s94, -v22
  v_fma_f32 v11, v11, s94, -v22
  v_exp_f32 v8, v8
  v_exp_f32 v9, v9
  v_exp_f32 v10, v10
  v_exp_f32 v11, v11
  v_mul_f32 v12, v12, v23
  v_mul_f32 v13, v13, v23
  v_mul_f32 v14, v14, v23
  v_mul_f32 v15, v15, v23
  v_mul_f32 v16, v16, v23
  v_mul_f32 v17, v17, v23
  v_mul_f32 v18, v18, v23
  v_mul_f32 v19, v19, v23
  v_add_f32 v24, v8, v9
  v_add_f32 v25, v10, v11
  v_add_f32 v24, v24, v25
  v_fma_f32 v21, v21, v23, v24
  v_cvt_pk_bf16_f32 v24, v8, v8
  v_cvt_pk_bf16_f32 v25, v9, v9
  v_cvt_pk_bf16_f32 v26, v10, v10
  v_cvt_pk_bf16_f32 v27, v11, v11
  v_and_b32 v64, v24, v4
  v_and_b32 v65, v24, v5
  v_and_b32 v66, v24, v6
  v_and_b32 v67, v24, v7
  v_and_b32 v68, v25, v4
  v_and_b32 v69, v25, v5
  v_and_b32 v70, v25, v6
  v_and_b32 v71, v25, v7
  v_and_b32 v72, v26, v4
  v_and_b32 v73, v26, v5
  v_and_b32 v74, v26, v6
  v_and_b32 v75, v26, v7
  v_and_b32 v76, v27, v4
  v_and_b32 v77, v27, v5
  v_and_b32 v78, v27, v6
  v_and_b32 v79, v27, v7
  s_waitcnt vmcnt(24)
  s_nop 1
  v_mfma_f32_16x16x32_bf16 v[12:15], a[128:131], v[64:67], v[12:15]
  v_mfma_f32_16x16x32_bf16 v[16:19], a[132:135], v[64:67], v[16:19]
  v_mfma_f32_16x16x32_bf16 v[12:15], a[136:139], v[68:71], v[12:15]
  v_mfma_f32_16x16x32_bf16 v[16:19], a[140:143], v[68:71], v[16:19]
  v_mfma_f32_16x16x32_bf16 v[12:15], a[144:147], v[72:75], v[12:15]
  v_mfma_f32_16x16x32_bf16 v[16:19], a[148:151], v[72:75], v[16:19]
  v_mfma_f32_16x16x32_bf16 v[12:15], a[152:155], v[76:79], v[12:15]
  v_mfma_f32_16x16x32_bf16 v[16:19], a[156:159], v[76:79], v[16:19]
  buffer_load_dwordx4 v[96:99], v3, s[32:35], s58 offen offset:0 nt
  buffer_load_dwordx4 v[100:103], v3, s[32:35], s58 offen offset:256 nt
  buffer_load_dwordx4 v[104:107], v3, s[32:35], s58 offen offset:512 nt
  buffer_load_dwordx4 v[108:111], v3, s[32:35], s58 offen offset:768 nt
  buffer_load_dwordx4 v[112:115], v3, s[32:35], s58 offen offset:1024 nt
  buffer_load_dwordx4 v[116:119], v3, s[32:35], s58 offen offset:1280 nt
  buffer_load_dwordx4 v[120:123], v3, s[32:35], s58 offen offset:1536 nt
  buffer_load_dwordx4 v[124:127], v3, s[32:35], s58 offen offset:1792 nt
  s_cmp_ge_u32 s57, 8388608
  s_cbranch_scc1 L_loopend
  s_waitcnt vmcnt(24)
  v_mfma_f32_16x16x32_bf16 v[8:11], a[160:163], v[32:35], 0
  v_mfma_f32_16x16x32_bf16 v[8:11], a[164:167], v[36:39], v[8:11]
  v_mfma_f32_16x16x32_bf16 v[8:11], a[168:171], v[40:43], v[8:11]
  v_mfma_f32_16x16x32_bf16 v[8:11], a[172:175], v[44:47], v[8:11]
  v_mfma_f32_16x16x32_bf16 v[8:11], a[176:179], v[48:51], v[8:11]
  v_mfma_f32_16x16x32_bf16 v[8:11], a[180:183], v[52:55], v[8:11]
  v_mfma_f32_16x16x32_bf16 v[8:11], a[184:187], v[56:59], v[8:11]
  v_mfma_f32_16x16x32_bf16 v[8:11], a[188:191], v[60:63], v[8:11]
  s_nop 7
  v_cvt_pk_bf16_f32 v22, v8, v9
  v_cvt_pk_bf16_f32 v23, v10, v11
  v_lshlrev_b32 v8, 16, v22
  v_and_b32 v9, 0xffff0000, v22
  v_lshlrev_b32 v10, 16, v23
  v_and_b32 v11, 0xffff0000, v23
  v_max3_f32 v22, v8, v9, v10
  v_max_f32 v22, v22, v11
  v_mov_b32 v23, v22
  s_nop 1
  v_permlane16_swap_b32 v22, v23
  s_nop 1
  v_max_f32 v22, v22, v23
  v_mov_b32 v23, v22
  s_nop 1
  v_permlane32_swap_b32 v22, v23
  s_nop 1
  v_max_f32 v22, v22, v23
  v_mul_f32 v22, s94, v22
  v_max_f32 v22, v22, v20
  v_sub_f32 v23, v20, v22
  v_exp_f32 v23, v23
  v_mov_b32 v20, v22
  v_fma_f32 v8, v8, s94, -v22
  v_fma_f32 v9, v9, s94, -v22
  v_fma_f32 v10, v10, s94, -v22
  v_fma_f32 v11, v11, s94, -v22
  v_exp_f32 v8, v8
  v_exp_f32 v9, v9
  v_exp_f32 v10, v10
  v_exp_f32 v11, v11
  v_mul_f32 v12, v12, v23
  v_mul_f32 v13, v13, v23
  v_mul_f32 v14, v14, v23
  v_mul_f32 v15, v15, v23
  v_mul_f32 v16, v16, v23
  v_mul_f32 v17, v17, v23
  v_mul_f32 v18, v18, v23
  v_mul_f32 v19, v19, v23
  v_add_f32 v24, v8, v9
  v_add_f32 v25, v10, v11
  v_add_f32 v24, v24, v25
  v_fma_f32 v21, v21, v23, v24
  v_cvt_pk_bf16_f32 v24, v8, v8
  v_cvt_pk_bf16_f32 v25, v9, v9
  v_cvt_pk_bf16_f32 v26, v10, v10
  v_cvt_pk_bf16_f32 v27, v11, v11
  v_and_b32 v64, v24, v4
  v_and_b32 v65, v24, v5
  v_and_b32 v66, v24, v6
  v_and_b32 v67, v24, v7
  v_and_b32 v68, v25, v4
  v_and_b32 v69, v25, v5
  v_and_b32 v70, v25, v6
  v_and_b32 v71, v25, v7
  v_and_b32 v72, v26, v4
  v_and_b32 v73, v26, v5
  v_and_b32 v74, v26, v6
  v_and_b32 v75, v26, v7
  v_and_b32 v76, v27, v4
  v_and_b32 v77, v27, v5
  v_and_b32 v78, v27, v6
  v_and_b32 v79, v27, v7
  s_waitcnt vmcnt(16)
  s_nop 1
  v_mfma_f32_16x16x32_bf16 v[12:15], a[192:195], v[64:67], v[12:15]
  v_mfma_f32_16x16x32_bf16 v[16:19], a[196:199], v[64:67], v[16:19]
  v_mfma_f32_16x16x32_bf16 v[12:15], a[200:203], v[68:71], v[12:15]
  v_mfma_f32_16x16x32_bf16 v[16:19], a[204:207], v[68:71], v[16:19]
  v_mfma_f32_16x16x32_bf16 v[12:15], a[208:211], v[72:75], v[12:15]
  v_mfma_f32_16x16x32_bf16 v[16:19], a[212:215], v[72:75], v[16:19]
  v_mfma_f32_16x16x32_bf16 v[12:15], a[216:219], v[76:79], v[12:15]
  v_mfma_f32_16x16x32_bf16 v[16:19], a[220:223], v[76:79], v[16:19]
  s_add_u32 s59, s93, 524288
  buffer_load_dwordx4 v[128:131], v2, s[28:31], s59 offen offset:0 nt
  buffer_load_dwordx4 v[132:135], v2, s[28:31], s59 offen offset:64 nt
  buffer_load_dwordx4 v[136:139], v2, s[28:31], s59 offen offset:128 nt
  buffer_load_dwordx4 v[140:143], v2, s[28:31], s59 offen offset:192 nt
  buffer_load_dwordx4 v[144:147], v2, s[28:31], s59 offen offset:256 nt
  buffer_load_dwordx4 v[148:151], v2, s[28:31], s59 offen offset:320 nt
  buffer_load_dwordx4 v[152:155], v2, s[28:31], s59 offen offset:384 nt
  buffer_load_dwordx4 v[156:159], v2, s[28:31], s59 offen offset:448 nt
  s_cmp_ge_u32 s58, 8388608
  s_cbranch_scc1 L_loopend
  s_waitcnt vmcnt(16)
  v_mfma_f32_16x16x32_bf16 v[8:11], a[224:227], v[32:35], 0
  v_mfma_f32_16x16x32_bf16 v[8:11], a[228:231], v[36:39], v[8:11]
  v_mfma_f32_16x16x32_bf16 v[8:11], a[232:235], v[40:43], v[8:11]
  v_mfma_f32_16x16x32_bf16 v[8:11], a[236:239], v[44:47], v[8:11]
  v_mfma_f32_16x16x32_bf16 v[8:11], a[240:243], v[48:51], v[8:11]
  v_mfma_f32_16x16x32_bf16 v[8:11], a[244:247], v[52:55], v[8:11]
  v_mfma_f32_16x16x32_bf16 v[8:11], a[248:251], v[56:59], v[8:11]
  v_mfma_f32_16x16x32_bf16 v[8:11], a[252:255], v[60:63], v[8:11]
  s_nop 7
  v_cvt_pk_bf16_f32 v22, v8, v9
  v_cvt_pk_bf16_f32 v23, v10, v11
  v_lshlrev_b32 v8, 16, v22
  v_and_b32 v9, 0xffff0000, v22
  v_lshlrev_b32 v10, 16, v23
  v_and_b32 v11, 0xffff0000, v23
  v_max3_f32 v22, v8, v9, v10
  v_max_f32 v22, v22, v11
  v_mov_b32 v23, v22
  s_nop 1
  v_permlane16_swap_b32 v22, v23
  s_nop 1
  v_max_f32 v22, v22, v23
  v_mov_b32 v23, v22
  s_nop 1
  v_permlane32_swap_b32 v22, v23
  s_nop 1
  v_max_f32 v22, v22, v23
  v_mul_f32 v22, s94, v22
  v_max_f32 v22, v22, v20
  v_sub_f32 v23, v20, v22
  v_exp_f32 v23, v23
  v_mov_b32 v20, v22
  v_fma_f32 v8, v8, s94, -v22
  v_fma_f32 v9, v9, s94, -v22
  v_fma_f32 v10, v10, s94, -v22
  v_fma_f32 v11, v11, s94, -v22
  v_exp_f32 v8, v8
  v_exp_f32 v9, v9
  v_exp_f32 v10, v10
  v_exp_f32 v11, v11
  v_mul_f32 v12, v12, v23
  v_mul_f32 v13, v13, v23
  v_mul_f32 v14, v14, v23
  v_mul_f32 v15, v15, v23
  v_mul_f32 v16, v16, v23
  v_mul_f32 v17, v17, v23
  v_mul_f32 v18, v18, v23
  v_mul_f32 v19, v19, v23
  v_add_f32 v24, v8, v9
  v_add_f32 v25, v10, v11
  v_add_f32 v24, v24, v25
  v_fma_f32 v21, v21, v23, v24
  v_cvt_pk_bf16_f32 v24, v8, v8
  v_cvt_pk_bf16_f32 v25, v9, v9
  v_cvt_pk_bf16_f32 v26, v10, v10
  v_cvt_pk_bf16_f32 v27, v11, v11
  v_and_b32 v64, v24, v4
  v_and_b32 v65, v24, v5
  v_and_b32 v66, v24, v6
  v_and_b32 v67, v24, v7
  v_and_b32 v68, v25, v4
  v_and_b32 v69, v25, v5
  v_and_b32 v70, v25, v6
  v_and_b32 v71, v25, v7
  v_and_b32 v72, v26, v4
  v_and_b32 v73, v26, v5
  v_and_b32 v74, v26, v6
  v_and_b32 v75, v26, v7
  v_and_b32 v76, v27, v4
  v_and_b32 v77, v27, v5
  v_and_b32 v78, v27, v6
  v_and_b32 v79, v27, v7
  s_waitcnt vmcnt(8)
  s_nop 1
  v_mfma_f32_16x16x32_bf16 v[12:15], v[96:99], v[64:67], v[12:15]
  v_mfma_f32_16x16x32_bf16 v[16:19], v[100:103], v[64:67], v[16:19]
  v_mfma_f32_16x16x32_bf16 v[12:15], v[104:107], v[68:71], v[12:15]
  v_mfma_f32_16x16x32_bf16 v[16:19], v[108:111], v[68:71], v[16:19]
  v_mfma_f32_16x16x32_bf16 v[12:15], v[112:115], v[72:75], v[12:15]
  v_mfma_f32_16x16x32_bf16 v[16:19], v[116:119], v[72:75], v[16:19]
  v_mfma_f32_16x16x32_bf16 v[12:15], v[120:123], v[76:79], v[12:15]
  v_mfma_f32_16x16x32_bf16 v[16:19], v[124:127], v[76:79], v[16:19]
  buffer_load_dwordx4 v[160:163], v3, s[32:35], s59 offen offset:0 nt
  buffer_load_dwordx4 v[164:167], v3, s[32:35], s59 offen offset:256 nt
  buffer_load_dwordx4 v[168:171], v3, s[32:35], s59 offen offset:512 nt
  buffer_load_dwordx4 v[172:175], v3, s[32:35], s59 offen offset:768 nt
  buffer_load_dwordx4 v[176:179], v3, s[32:35], s59 offen offset:1024 nt
  buffer_load_dwordx4 v[180:183], v3, s[32:35], s59 offen offset:1280 nt
  buffer_load_dwordx4 v[184:187], v3, s[32:35], s59 offen offset:1536 nt
  buffer_load_dwordx4 v[188:191], v3, s[32:35], s59 offen offset:1792 nt
  s_mov_b32 s49, s59
  s_mov_b32 s56, s49
  s_add_u32 s49, s93, 655360
  s_lshr_b32 s49, s49, 13
  v_mov_b32 v80, s49
L_loop:
  s_cmp_ge_u32 s56, 8388608
  s_cbranch_scc1 L_loopend
  s_waitcnt lgkmcnt(0)
  v_readfirstlane_b32 s49, v80
  s_nop 0
  s_cmp_eq_u32 s49, -1
  s_cbranch_scc1 L_empty0
L_entryok0:
  s_min_u32 s49, s49, 1024
  s_lshl_b32 s57, s49, 13
  s_mov_b64 exec, s[64:65]
  ds_add_rtn_u32 v82, v84, v83
  s_mov_b64 exec, -1
  s_waitcnt vmcnt(15)
  v_mfma_f32_16x16x32_bf16 v[8:11], v[128:131], v[32:35], 0
  buffer_load_dwordx4 v[128:131], v2, s[28:31], s57 offen offset:0 nt
  s_waitcnt vmcnt(15)
  v_mfma_f32_16x16x32_bf16 v[8:11], v[132:135], v[36:39], v[8:11]
  buffer_load_dwordx4 v[132:135], v2, s[28:31], s57 offen offset:64 nt
  s_waitcnt vmcnt(15)
  v_mfma_f32_16x16x32_bf16 v[8:11], v[136:139], v[40:43], v[8:11]
  buffer_load_dwordx4 v[136:139], v2, s[28:31], s57 offen offset:128 nt
  s_waitcnt vmcnt(15)
  v_mfma_f32_16x16x32_bf16 v[8:11], v[140:143], v[44:47], v[8:11]
  buffer_load_dwordx4 v[140:143], v2, s[28:31], s57 offen offset:192 nt
  s_waitcnt vmcnt(15)
  v_mfma_f32_16x16x32_bf16 v[8:11], v[144:147], v[48:51], v[8:11]
  buffer_load_dwordx4 v[144:147], v2, s[28:31], s57 offen offset:256 nt
  s_waitcnt vmcnt(15)
  v_mfma_f32_16x16x32_bf16 v[8:11], v[148:151], v[52:55], v[8:11]
  buffer_load_dwordx4 v[148:151], v2, s[28:31], s57 offen offset:320 nt
  s_waitcnt vmcnt(15)
  v_mfma_f32_16x16x32_bf16 v[8:11], v[152:155], v[56:59], v[8:11]
  buffer_load_dwordx4 v[152:155], v2, s[28:31], s57 offen offset:384 nt
  s_waitcnt vmcnt(15)
  v_mfma_f32_16x16x32_bf16 v[8:11], v[156:159], v[60:63], v[8:11]
  buffer_load_dwordx4 v[156:159], v2, s[28:31], s57 offen offset:448 nt
  s_nop 7
  v_cvt_pk_bf16_f32 v22, v8, v9
  v_cvt_pk_bf16_f32 v23, v10, v11
  v_lshlrev_b32 v8, 16, v22
  v_and_b32 v9, 0xffff0000, v22
  v_lshlrev_b32 v10, 16, v23
  v_and_b32 v11, 0xffff0000, v23
  v_max3_f32 v22, v8, v9, v10
  v_max_f32 v22, v22, v11
  v_mov_b32 v23, v22
  s_nop 1
  v_permlane16_swap_b32 v22, v23
  s_nop 1
  v_max_f32 v22, v22, v23
  v_mov_b32 v23, v22
  s_nop 1
  v_permlane32_swap_b32 v22, v23
  s_nop 1
  v_max_f32 v22, v22, v23
  v_mul_f32 v22, s94, v22
  v_max_f32 v22, v22, v20
  v_sub_f32 v23, v20, v22
  v_exp_f32 v23, v23
  v_mov_b32 v20, v22
  v_fma_f32 v8, v8, s94, -v22
  v_fma_f32 v9, v9, s94, -v22
  v_fma_f32 v10, v10, s94, -v22
  v_fma_f32 v11, v11, s94, -v22
  v_exp_f32 v8, v8
  v_exp_f32 v9, v9
  v_exp_f32 v10, v10
  v_exp_f32 v11, v11
  v_mul_f32 v12, v12, v23
  v_mul_f32 v13, v13, v23
  v_mul_f32 v14, v14, v23
  v_mul_f32 v15, v15, v23
  v_mul_f32 v16, v16, v23
  v_mul_f32 v17, v17, v23
  v_mul_f32 v18, v18, v23
  v_mul_f32 v19, v19, v23
  v_add_f32 v24, v8, v9
  v_add_f32 v25, v10, v11
  v_add_f32 v24, v24, v25
  v_fma_f32 v21, v21, v23, v24
  v_cvt_pk_bf16_f32 v24, v8, v8
  v_cvt_pk_bf16_f32 v25, v9, v9
  v_cvt_pk_bf16_f32 v26, v10, v10
  v_cvt_pk_bf16_f32 v27, v11, v11
  v_and_b32 v64, v24, v4
  v_and_b32 v65, v24, v5
  v_and_b32 v66, v24, v6
  v_and_b32 v67, v24, v7
  v_and_b32 v68, v25, v4
  v_and_b32 v69, v25, v5
  v_and_b32 v70, v25, v6
  v_and_b32 v71, v25, v7
  v_and_b32 v72, v26, v4
  v_and_b32 v73, v26, v5
  v_and_b32 v74, v26, v6
  v_and_b32 v75, v26, v7
  v_and_b32 v76, v27, v4
  v_and_b32 v77, v27, v5
  v_and_b32 v78, v27, v6
  v_and_b32 v79, v27, v7
  s_waitcnt lgkmcnt(0)
  s_mov_b64 exec, s[64:65]
  v_lshlrev_b32 v82, 2, v82
  ds_read_b32 v80, v82 offset:12288
  v_mov_b32 v81, v82
  s_mov_b64 exec, -1
  s_waitcnt vmcnt(15)
  v_mfma_f32_16x16x32_bf16 v[12:15], v[160:163], v[64:67], v[12:15]
  buffer_load_dwordx4 v[160:163], v3, s[32:35], s57 offen offset:0 nt
  s_waitcnt vmcnt(15)
  v_mfma_f32_16x16x32_bf16 v[16:19], v[164:167], v[64:67], v[16:19]
  buffer_load_dwordx4 v[164:167], v3, s[32:35], s57 offen offset:256 nt
  s_waitcnt vmcnt(15)
  v_mfma_f32_16x16x32_bf16 v[12:15], v[168:171], v[68:71], v[12:15]
  buffer_load_dwordx4 v[168:171], v3, s[32:35], s57 offen offset:512 nt
  s_waitcnt vmcnt(15)
  v_mfma_f32_16x16x32_bf16 v[16:19], v[172:175], v[68:71], v[16:19]
  buffer_load_dwordx4 v[172:175], v3, s[32:35], s57 offen offset:768 nt
  s_waitcnt vmcnt(15)
  v_mfma_f32_16x16x32_bf16 v[12:15], v[176:179], v[72:75], v[12:15]
  buffer_load_dwordx4 v[176:179], v3, s[32:35], s57 offen offset:1024 nt
  s_waitcnt vmcnt(15)
  v_mfma_f32_16x16x32_bf16 v[16:19], v[180:183], v[72:75], v[16:19]
  buffer_load_dwordx4 v[180:183], v3, s[32:35], s57 offen offset:1280 nt
  s_waitcnt vmcnt(15)
  v_mfma_f32_16x16x32_bf16 v[12:15], v[184:187], v[76:79], v[12:15]
  buffer_load_dwordx4 v[184:187], v3, s[32:35], s57 offen offset:1536 nt
  s_waitcnt vmcnt(15)
  v_mfma_f32_16x16x32_bf16 v[16:19], v[188:191], v[76:79], v[16:19]
  buffer_load_dwordx4 v[188:191], v3, s[32:35], s57 offen offset:1792 nt
  s_mov_b32 s56, s57
  s_branch L_loop
L_empty0:
  s_mov_b32 s66, 0
L_emptyl0:
  s_sleep 1
  ds_read_b32 v80, v81 offset:12288
  s_waitcnt lgkmcnt(0)
  v_readfirstlane_b32 s49, v80
  s_nop 0
  s_cmp_eq_u32 s49, -1
  s_cbranch_scc0 L_entryok0
  s_add_u32 s66, s66, 1
  s_cmp_lt_u32 s66, 1048576
  s_cbranch_scc1 L_emptyl0
  s_mov_b32 s49, 1024
  s_branch L_entryok0
L_loopend:
  s_waitcnt vmcnt(0)
  s_branch L_combine
L_helper2:
  s_lshl_b32 s49, s44, 9
  s_lshl_b32 s50, s45, 4
  s_add_u32 s49, s49, s50
  s_mul_i32 s49, s49, 896
  s_add_u32 s36, s12, s49
  s_addc_u32 s37, s13, 0
  s_mov_b32 s38, 14336
  s_mov_b32 s39, 0x00020000
  v_lshlrev_b32 v22, 4, v1
  s_mov_b32 s50, 0
  buffer_load_dwordx4 v[144:147], v22, s[36:39], s50 offen nt
  s_mov_b32 s50, 896
  buffer_load_dwordx4 v[148:151], v22, s[36:39], s50 offen nt
  s_mov_b32 s50, 1792
  buffer_load_dwordx4 v[152:155], v22, s[36:39], s50 offen nt
  s_mov_b32 s50, 2688
  buffer_load_dwordx4 v[156:159], v22, s[36:39], s50 offen nt
  s_mov_b32 s50, 3584
  buffer_load_dwordx4 v[160:163], v22, s[36:39], s50 offen nt
  s_mov_b32 s50, 4480
  buffer_load_dwordx4 v[164:167], v22, s[36:39], s50 offen nt
  s_mov_b32 s50, 5376
  buffer_load_dwordx4 v[168:171], v22, s[36:39], s50 offen nt
  s_mov_b32 s50, 6272
  buffer_load_dwordx4 v[172:175], v22, s[36:39], s50 offen nt
  s_mov_b32 s50, 7168
  buffer_load_dwordx4 v[176:179], v22, s[36:39], s50 offen nt
  s_mov_b32 s50, 8064
  buffer_load_dwordx4 v[180:183], v22, s[36:39], s50 offen nt
  s_mov_b32 s50, 8960
  buffer_load_dwordx4 v[184:187], v22, s[36:39], s50 offen nt
  s_mov_b32 s50, 9856
  buffer_load_dwordx4 v[188:191], v22, s[36:39], s50 offen nt
  s_mov_b32 s50, 10752
  buffer_load_dwordx4 v[192:195], v22, s[36:39], s50 offen nt
  s_mov_b32 s50, 11648
  buffer_load_dwordx4 v[196:199], v22, s[36:39], s50 offen nt
  s_mov_b32 s50, 12544
  buffer_load_dwordx4 v[200:203], v22, s[36:39], s50 offen nt
  s_mov_b32 s50, 13440
  buffer_load_dwordx4 v[204:207], v22, s[36:39], s50 offen nt
  s_mov_b32 s49, 0x05040100
  s_mov_b32 s50, 0x07060302
  s_waitcnt vmcnt(0)
  v_perm_b32 v80, v148, v144, s49
  v_perm_b32 v81, v148, v144, s50
  v_perm_b32 v82, v149, v145, s49
  v_perm_b32 v83, v149, v145, s50
  v_perm_b32 v84, v150, v146, s49
  v_perm_b32 v85, v150, v146, s50
  v_perm_b32 v86, v151, v147, s49
  v_perm_b32 v87, v151, v147, s50
  v_perm_b32 v88, v156, v152, s49
  v_perm_b32 v89, v156, v152, s50
  v_perm_b32 v90, v157, v153, s49
  v_perm_b32 v91, v157, v153, s50
  v_perm_b32 v92, v158, v154, s49
  v_perm_b32 v93, v158, v154, s50
  v_perm_b32 v94, v159, v155, s49
  v_perm_b32 v95, v159, v155, s50
  v_perm_b32 v96, v164, v160, s49
  v_perm_b32 v97, v164, v160, s50
  v_perm_b32 v98, v165, v161, s49
  v_perm_b32 v99, v165, v161, s50
  v_perm_b32 v100, v166, v162, s49
  v_perm_b32 v101, v166, v162, s50
  v_perm_b32 v102, v167, v163, s49
  v_perm_b32 v103, v167, v163, s50
  v_perm_b32 v104, v172, v168, s49
  v_perm_b32 v105, v172, v168, s50
  v_perm_b32 v106, v173, v169, s49
  v_perm_b32 v107, v173, v169, s50
  v_perm_b32 v108, v174, v170, s49
  v_perm_b32 v109, v174, v170, s50
  v_perm_b32 v110, v175, v171, s49
  v_perm_b32 v111, v175, v171, s50
  v_perm_b32 v112, v180, v176, s49
  v_perm_b32 v113, v180, v176, s50
  v_perm_b32 v114, v181, v177, s49
  v_perm_b32 v115, v181, v177, s50
  v_perm_b32 v116, v182, v178, s49
  v_perm_b32 v117, v182, v178, s50
  v_perm_b32 v118, v183, v179, s49
  v_perm_b32 v119, v183, v179, s50
  v_perm_b32 v120, v188, v184, s49
  v_perm_b32 v121, v188, v184, s50
  v_perm_b32 v122, v189, v185, s49
  v_perm_b32 v123, v189, v185, s50
  v_perm_b32 v124, v190, v186, s49
  v_perm_b32 v125, v190, v186, s50
  v_perm_b32 v126, v191, v187, s49
  v_perm_b32 v127, v191, v187, s50
  v_perm_b32 v128, v196, v192, s49
  v_perm_b32 v129, v196, v192, s50
  v_perm_b32 v130, v197, v193, s49
  v_perm_b32 v131, v197, v193, s50
  v_perm_b32 v132, v198, v194, s49
  v_perm_b32 v133, v198, v194, s50
  v_perm_b32 v134, v199, v195, s49
  v_perm_b32 v135, v199, v195, s50
  v_perm_b32 v136, v204, v200, s49
  v_perm_b32 v137, v204, v200, s50
  v_perm_b32 v138, v205, v201, s49
  v_perm_b32 v139, v205, v201, s50
  v_perm_b32 v140, v206, v202, s49
  v_perm_b32 v141, v206, v202, s50
  v_perm_b32 v142, v207, v203, s49
  v_perm_b32 v143, v207, v203, s50
  s_lshr_b32 s58, s2, 3
  s_cmp_eq_u32 s95, 4
  s_cselect_b32 s58, s58, 255
  s_cmp_lt_u32 s58, 28
  s_cbranch_scc0 L_nomlp
  s_lshl_b32 s49, s58, 7
  s_sub_u32 s50, 1605632, s49
  s_add_u32 s36, s16, s49
  s_addc_u32 s37, s17, 0
  s_mov_b32 s38, s50
  s_mov_b32 s39, 0x00020000
  s_add_u32 s40, s18, s49
  s_addc_u32 s41, s19, 0
  s_mov_b32 s42, s50
  s_mov_b32 s43, 0x00020000
  v_lshrrev_b32 v22, 3, v1
  v_lshlrev_b32 v23, 2, v22
  v_mul_u32_u24 v22, 3584, v22
  v_and_b32 v24, 7, v1
  v_lshl_add_u32 v22, v24, 4, v22
  v_mov_b32 v64, 0
  v_mov_b32 v65, 0
  v_mov_b32 v66, 0
  v_mov_b32 v67, 0
  v_mov_b32 v68, 0
  v_mov_b32 v69, 0
  v_mov_b32 v70, 0
  v_mov_b32 v71, 0
  v_mov_b32 v72, 0
  v_mov_b32 v73, 0
  v_mov_b32 v74, 0
  v_mov_b32 v75, 0
  v_mov_b32 v76, 0
  v_mov_b32 v77, 0
  v_mov_b32 v78, 0
  v_mov_b32 v79, 0
  s_mov_b32 s56, 0
  s_mov_b32 s57, 0
L_gu:
  buffer_load_dwordx4 v[144:147], v22, s[36:39], s56 offen nt
  buffer_load_dwordx4 v[148:151], v22, s[40:43], s56 offen nt
  s_add_u32 s56, s56, 28672
  buffer_load_dwordx4 v[152:155], v22, s[36:39], s56 offen nt
  buffer_load_dwordx4 v[156:159], v22, s[40:43], s56 offen nt
  s_add_u32 s56, s56, 28672
  buffer_load_dwordx4 v[160:163], v22, s[36:39], s56 offen nt
  buffer_load_dwordx4 v[164:167], v22, s[40:43], s56 offen nt
  s_add_u32 s56, s56, 28672
  buffer_load_dwordx4 v[168:171], v22, s[36:39], s56 offen nt
  buffer_load_dwordx4 v[172:175], v22, s[40:43], s56 offen nt
  s_add_u32 s56, s56, 28672
  buffer_load_dwordx4 v[176:179], v22, s[36:39], s56 offen nt
  buffer_load_dwordx4 v[180:183], v22, s[40:43], s56 offen nt
  s_add_u32 s56, s56, 28672
  buffer_load_dwordx4 v[184:187], v22, s[36:39], s56 offen nt
  buffer_load_dwordx4 v[188:191], v22, s[40:43], s56 offen nt
  s_add_u32 s56, s56, 28672
  buffer_load_dwordx4 v[192:195], v22, s[36:39], s56 offen nt
  buffer_load_dwordx4 v[196:199], v22, s[40:43], s56 offen nt
  s_add_u32 s56, s56, 28672
  buffer_load_dwordx4 v[200:203], v22, s[36:39], s56 offen nt
  buffer_load_dwordx4 v[204:207], v22, s[40:43], s56 offen nt
  s_add_u32 s56, s56, 28672
  buffer_load_dwordx4 v[208:211], v22, s[36:39], s56 offen nt
  buffer_load_dwordx4 v[212:215], v22, s[40:43], s56 offen nt
  s_add_u32 s56, s56, 28672
  buffer_load_dwordx4 v[216:219], v22, s[36:39], s56 offen nt
  buffer_load_dwordx4 v[220:223], v22, s[40:43], s56 offen nt
  s_add_u32 s56, s56, 28672
  buffer_load_dwordx4 v[224:227], v22, s[36:39], s56 offen nt
  buffer_load_dwordx4 v[228:231], v22, s[40:43], s56 offen nt
  s_add_u32 s56, s56, 28672
  buffer_load_dwordx4 v[232:235], v22, s[36:39], s56 offen nt
  buffer_load_dwordx4 v[236:239], v22, s[40:43], s56 offen nt
  s_add_u32 s56, s56, 28672
  buffer_load_dwordx4 v[240:243], v22, s[36:39], s56 offen nt
  buffer_load_dwordx4 v[244:247], v22, s[40:43], s56 offen nt
  s_add_u32 s56, s56, 28672
  buffer_load_dwordx4 v[248:251], v22, s[36:39], s56 offen nt
  buffer_load_dwordx4 v[252:255], v22, s[40:43], s56 offen nt
  s_add_u32 s56, s56, 28672
  ds_read_b32 v32, v23 offset:2048
  ds_read_b32 v33, v23 offset:2080
  ds_read_b32 v34, v23 offset:2112
  ds_read_b32 v35, v23 offset:2144
  ds_read_b32 v36, v23 offset:2176
  ds_read_b32 v37, v23 offset:2208
  ds_read_b32 v38, v23 offset:2240
  ds_read_b32 v39, v23 offset:2272
  ds_read_b32 v40, v23 offset:2304
  ds_read_b32 v41, v23 offset:2336
  ds_read_b32 v42, v23 offset:2368
  ds_read_b32 v43, v23 offset:2400
  ds_read_b32 v44, v23 offset:2432
  ds_read_b32 v45, v23 offset:2464
  v_add_u32 v23, 448, v23
  s_waitcnt lgkmcnt(0)
  s_waitcnt vmcnt(26)
  v_lshrrev_b32 v24, 16, v32
  v_dot2_f32_bf16 v64, v144, v24, v64
  v_dot2_f32_bf16 v65, v144, v32, v65
  v_dot2_f32_bf16 v66, v145, v24, v66
  v_dot2_f32_bf16 v67, v145, v32, v67
  v_dot2_f32_bf16 v68, v146, v24, v68
  v_dot2_f32_bf16 v69, v146, v32, v69
  v_dot2_f32_bf16 v70, v147, v24, v70
  v_dot2_f32_bf16 v71, v147, v32, v71
  v_dot2_f32_bf16 v72, v148, v24, v72
  v_dot2_f32_bf16 v73, v148, v32, v73
  v_dot2_f32_bf16 v74, v149, v24, v74
  v_dot2_f32_bf16 v75, v149, v32, v75
  v_dot2_f32_bf16 v76, v150, v24, v76
  v_dot2_f32_bf16 v77, v150, v32, v77
  v_dot2_f32_bf16 v78, v151, v24, v78
  v_dot2_f32_bf16 v79, v151, v32, v79
  s_waitcnt vmcnt(24)
  v_lshrrev_b32 v24, 16, v33
  v_dot2_f32_bf16 v64, v152, v24, v64
  v_dot2_f32_bf16 v65, v152, v33, v65
  v_dot2_f32_bf16 v66, v153, v24, v66
  v_dot2_f32_bf16 v67, v153, v33, v67
  v_dot2_f32_bf16 v68, v154, v24, v68
  v_dot2_f32_bf16 v69, v154, v33, v69
  v_dot2_f32_bf16 v70, v155, v24, v70
  v_dot2_f32_bf16 v71, v155, v33, v71
  v_dot2_f32_bf16 v72, v156, v24, v72
  v_dot2_f32_bf16 v73, v156, v33, v73
  v_dot2_f32_bf16 v74, v157, v24, v74
  v_dot2_f32_bf16 v75, v157, v33, v75
  v_dot2_f32_bf16 v76, v158, v24, v76
  v_dot2_f32_bf16 v77, v158, v33, v77
  v_dot2_f32_bf16 v78, v159, v24, v78
  v_dot2_f32_bf16 v79, v159, v33, v79
  s_waitcnt vmcnt(22)
  v_lshrrev_b32 v24, 16, v34
  v_dot2_f32_bf16 v64, v160, v24, v64
  v_dot2_f32_bf16 v65, v160, v34, v65
  v_dot2_f32_bf16 v66, v161, v24, v66
  v_dot2_f32_bf16 v67, v161, v34, v67
  v_dot2_f32_bf16 v68, v162, v24, v68
  v_dot2_f32_bf16 v69, v162, v34, v69
  v_dot2_f32_bf16 v70, v163, v24, v70
  v_dot2_f32_bf16 v71, v163, v34, v71
  v_dot2_f32_bf16 v72, v164, v24, v72
  v_dot2_f32_bf16 v73, v164, v34, v73
  v_dot2_f32_bf16 v74, v165, v24, v74
  v_dot2_f32_bf16 v75, v165, v34, v75
  v_dot2_f32_bf16 v76, v166, v24, v76
  v_dot2_f32_bf16 v77, v166, v34, v77
  v_dot2_f32_bf16 v78, v167, v24, v78
  v_dot2_f32_bf16 v79, v167, v34, v79
  s_waitcnt vmcnt(20)
  v_lshrrev_b32 v24, 16, v35
  v_dot2_f32_bf16 v64, v168, v24, v64
  v_dot2_f32_bf16 v65, v168, v35, v65
  v_dot2_f32_bf16 v66, v169, v24, v66
  v_dot2_f32_bf16 v67, v169, v35, v67
  v_dot2_f32_bf16 v68, v170, v24, v68
  v_dot2_f32_bf16 v69, v170, v35, v69
  v_dot2_f32_bf16 v70, v171, v24, v70
  v_dot2_f32_bf16 v71, v171, v35, v71
  v_dot2_f32_bf16 v72, v172, v24, v72
  v_dot2_f32_bf16 v73, v172, v35, v73
  v_dot2_f32_bf16 v74, v173, v24, v74
  v_dot2_f32_bf16 v75, v173, v35, v75
  v_dot2_f32_bf16 v76, v174, v24, v76
  v_dot2_f32_bf16 v77, v174, v35, v77
  v_dot2_f32_bf16 v78, v175, v24, v78
  v_dot2_f32_bf16 v79, v175, v35, v79
  s_waitcnt vmcnt(18)
  v_lshrrev_b32 v24, 16, v36
  v_dot2_f32_bf16 v64, v176, v24, v64
  v_dot2_f32_bf16 v65, v176, v36, v65
  v_dot2_f32_bf16 v66, v177, v24, v66
  v_dot2_f32_bf16 v67, v177, v36, v67
  v_dot2_f32_bf16 v68, v178, v24, v68
  v_dot2_f32_bf16 v69, v178, v36, v69
  v_dot2_f32_bf16 v70, v179, v24, v70
  v_dot2_f32_bf16 v71, v179, v36, v71
  v_dot2_f32_bf16 v72, v180, v24, v72
  v_dot2_f32_bf16 v73, v180, v36, v73
  v_dot2_f32_bf16 v74, v181, v24, v74
  v_dot2_f32_bf16 v75, v181, v36, v75
  v_dot2_f32_bf16 v76, v182, v24, v76
  v_dot2_f32_bf16 v77, v182, v36, v77
  v_dot2_f32_bf16 v78, v183, v24, v78
  v_dot2_f32_bf16 v79, v183, v36, v79
  s_waitcnt vmcnt(16)
  v_lshrrev_b32 v24, 16, v37
  v_dot2_f32_bf16 v64, v184, v24, v64
  v_dot2_f32_bf16 v65, v184, v37, v65
  v_dot2_f32_bf16 v66, v185, v24, v66
  v_dot2_f32_bf16 v67, v185, v37, v67
  v_dot2_f32_bf16 v68, v186, v24, v68
  v_dot2_f32_bf16 v69, v186, v37, v69
  v_dot2_f32_bf16 v70, v187, v24, v70
  v_dot2_f32_bf16 v71, v187, v37, v71
  v_dot2_f32_bf16 v72, v188, v24, v72
  v_dot2_f32_bf16 v73, v188, v37, v73
  v_dot2_f32_bf16 v74, v189, v24, v74
  v_dot2_f32_bf16 v75, v189, v37, v75
  v_dot2_f32_bf16 v76, v190, v24, v76
  v_dot2_f32_bf16 v77, v190, v37, v77
  v_dot2_f32_bf16 v78, v191, v24, v78
  v_dot2_f32_bf16 v79, v191, v37, v79
  s_waitcnt vmcnt(14)
  v_lshrrev_b32 v24, 16, v38
  v_dot2_f32_bf16 v64, v192, v24, v64
  v_dot2_f32_bf16 v65, v192, v38, v65
  v_dot2_f32_bf16 v66, v193, v24, v66
  v_dot2_f32_bf16 v67, v193, v38, v67
  v_dot2_f32_bf16 v68, v194, v24, v68
  v_dot2_f32_bf16 v69, v194, v38, v69
  v_dot2_f32_bf16 v70, v195, v24, v70
  v_dot2_f32_bf16 v71, v195, v38, v71
  v_dot2_f32_bf16 v72, v196, v24, v72
  v_dot2_f32_bf16 v73, v196, v38, v73
  v_dot2_f32_bf16 v74, v197, v24, v74
  v_dot2_f32_bf16 v75, v197, v38, v75
  v_dot2_f32_bf16 v76, v198, v24, v76
  v_dot2_f32_bf16 v77, v198, v38, v77
  v_dot2_f32_bf16 v78, v199, v24, v78
  v_dot2_f32_bf16 v79, v199, v38, v79
  s_waitcnt vmcnt(12)
  v_lshrrev_b32 v24, 16, v39
  v_dot2_f32_bf16 v64, v200, v24, v64
  v_dot2_f32_bf16 v65, v200, v39, v65
  v_dot2_f32_bf16 v66, v201, v24, v66
  v_dot2_f32_bf16 v67, v201, v39, v67
  v_dot2_f32_bf16 v68, v202, v24, v68
  v_dot2_f32_bf16 v69, v202, v39, v69
  v_dot2_f32_bf16 v70, v203, v24, v70
  v_dot2_f32_bf16 v71, v203, v39, v71
  v_dot2_f32_bf16 v72, v204, v24, v72
  v_dot2_f32_bf16 v73, v204, v39, v73
  v_dot2_f32_bf16 v74, v205, v24, v74
  v_dot2_f32_bf16 v75, v205, v39, v75
  v_dot2_f32_bf16 v76, v206, v24, v76
  v_dot2_f32_bf16 v77, v206, v39, v77
  v_dot2_f32_bf16 v78, v207, v24, v78
  v_dot2_f32_bf16 v79, v207, v39, v79
  s_waitcnt vmcnt(10)
  v_lshrrev_b32 v24, 16, v40
  v_dot2_f32_bf16 v64, v208, v24, v64
  v_dot2_f32_bf16 v65, v208, v40, v65
  v_dot2_f32_bf16 v66, v209, v24, v66
  v_dot2_f32_bf16 v67, v209, v40, v67
  v_dot2_f32_bf16 v68, v210, v24, v68
  v_dot2_f32_bf16 v69, v210, v40, v69
  v_dot2_f32_bf16 v70, v211, v24, v70
  v_dot2_f32_bf16 v71, v211, v40, v71
  v_dot2_f32_bf16 v72, v212, v24, v72
  v_dot2_f32_bf16 v73, v212, v40, v73
  v_dot2_f32_bf16 v74, v213, v24, v74
  v_dot2_f32_bf16 v75, v213, v40, v75
  v_dot2_f32_bf16 v76, v214, v24, v76
  v_dot2_f32_bf16 v77, v214, v40, v77
  v_dot2_f32_bf16 v78, v215, v24, v78
  v_dot2_f32_bf16 v79, v215, v40, v79
  s_waitcnt vmcnt(8)
  v_lshrrev_b32 v24, 16, v41
  v_dot2_f32_bf16 v64, v216, v24, v64
  v_dot2_f32_bf16 v65, v216, v41, v65
  v_dot2_f32_bf16 v66, v217, v24, v66
  v_dot2_f32_bf16 v67, v217, v41, v67
  v_dot2_f32_bf16 v68, v218, v24, v68
  v_dot2_f32_bf16 v69, v218, v41, v69
  v_dot2_f32_bf16 v70, v219, v24, v70
  v_dot2_f32_bf16 v71, v219, v41, v71
  v_dot2_f32_bf16 v72, v220, v24, v72
  v_dot2_f32_bf16 v73, v220, v41, v73
  v_dot2_f32_bf16 v74, v221, v24, v74
  v_dot2_f32_bf16 v75, v221, v41, v75
  v_dot2_f32_bf16 v76, v222, v24, v76
  v_dot2_f32_bf16 v77, v222, v41, v77
  v_dot2_f32_bf16 v78, v223, v24, v78
  v_dot2_f32_bf16 v79, v223, v41, v79
  s_waitcnt vmcnt(6)
  v_lshrrev_b32 v24, 16, v42
  v_dot2_f32_bf16 v64, v224, v24, v64
  v_dot2_f32_bf16 v65, v224, v42, v65
  v_dot2_f32_bf16 v66, v225, v24, v66
  v_dot2_f32_bf16 v67, v225, v42, v67
  v_dot2_f32_bf16 v68, v226, v24, v68
  v_dot2_f32_bf16 v69, v226, v42, v69
  v_dot2_f32_bf16 v70, v227, v24, v70
  v_dot2_f32_bf16 v71, v227, v42, v71
  v_dot2_f32_bf16 v72, v228, v24, v72
  v_dot2_f32_bf16 v73, v228, v42, v73
  v_dot2_f32_bf16 v74, v229, v24, v74
  v_dot2_f32_bf16 v75, v229, v42, v75
  v_dot2_f32_bf16 v76, v230, v24, v76
  v_dot2_f32_bf16 v77, v230, v42, v77
  v_dot2_f32_bf16 v78, v231, v24, v78
  v_dot2_f32_bf16 v79, v231, v42, v79
  s_waitcnt vmcnt(4)
  v_lshrrev_b32 v24, 16, v43
  v_dot2_f32_bf16 v64, v232, v24, v64
  v_dot2_f32_bf16 v65, v232, v43, v65
  v_dot2_f32_bf16 v66, v233, v24, v66
  v_dot2_f32_bf16 v67, v233, v43, v67
  v_dot2_f32_bf16 v68, v234, v24, v68
  v_dot2_f32_bf16 v69, v234, v43, v69
  v_dot2_f32_bf16 v70, v235, v24, v70
  v_dot2_f32_bf16 v71, v235, v43, v71
  v_dot2_f32_bf16 v72, v236, v24, v72
  v_dot2_f32_bf16 v73, v236, v43, v73
  v_dot2_f32_bf16 v74, v237, v24, v74
  v_dot2_f32_bf16 v75, v237, v43, v75
  v_dot2_f32_bf16 v76, v238, v24, v76
  v_dot2_f32_bf16 v77, v238, v43, v77
  v_dot2_f32_bf16 v78, v239, v24, v78
  v_dot2_f32_bf16 v79, v239, v43, v79
  s_waitcnt vmcnt(2)
  v_lshrrev_b32 v24, 16, v44
  v_dot2_f32_bf16 v64, v240, v24, v64
  v_dot2_f32_bf16 v65, v240, v44, v65
  v_dot2_f32_bf16 v66, v241, v24, v66
  v_dot2_f32_bf16 v67, v241, v44, v67
  v_dot2_f32_bf16 v68, v242, v24, v68
  v_dot2_f32_bf16 v69, v242, v44, v69
  v_dot2_f32_bf16 v70, v243, v24, v70
  v_dot2_f32_bf16 v71, v243, v44, v71
  v_dot2_f32_bf16 v72, v244, v24, v72
  v_dot2_f32_bf16 v73, v244, v44, v73
  v_dot2_f32_bf16 v74, v245, v24, v74
  v_dot2_f32_bf16 v75, v245, v44, v75
  v_dot2_f32_bf16 v76, v246, v24, v76
  v_dot2_f32_bf16 v77, v246, v44, v77
  v_dot2_f32_bf16 v78, v247, v24, v78
  v_dot2_f32_bf16 v79, v247, v44, v79
  s_waitcnt vmcnt(0)
  v_lshrrev_b32 v24, 16, v45
  v_dot2_f32_bf16 v64, v248, v24, v64
  v_dot2_f32_bf16 v65, v248, v45, v65
  v_dot2_f32_bf16 v66, v249, v24, v66
  v_dot2_f32_bf16 v67, v249, v45, v67
  v_dot2_f32_bf16 v68, v250, v24, v68
  v_dot2_f32_bf16 v69, v250, v45, v69
  v_dot2_f32_bf16 v70, v251, v24, v70
  v_dot2_f32_bf16 v71, v251, v45, v71
  v_dot2_f32_bf16 v72, v252, v24, v72
  v_dot2_f32_bf16 v73, v252, v45, v73
  v_dot2_f32_bf16 v74, v253, v24, v74
  v_dot2_f32_bf16 v75, v253, v45, v75
  v_dot2_f32_bf16 v76, v254, v24, v76
  v_dot2_f32_bf16 v77, v254, v45, v77
  v_dot2_f32_bf16 v78, v255, v24, v78
  v_dot2_f32_bf16 v79, v255, v45, v79
  s_add_u32 s57, s57, 1
  s_cmp_lt_u32 s57, 4
  s_cbranch_scc1 L_gu
  s_nop 1
  v_permlane32_swap_b32 v64, v72
  v_permlane32_swap_b32 v65, v73
  v_permlane32_swap_b32 v66, v74
  v_permlane32_swap_b32 v67, v75
  v_permlane32_swap_b32 v68, v76
  v_permlane32_swap_b32 v69, v77
  v_permlane32_swap_b32 v70, v78
  v_permlane32_swap_b32 v71, v79
  s_nop 1
  v_add_f32 v64, v64, v72
  v_add_f32 v65, v65, v73
  v_add_f32 v66, v66, v74
  v_add_f32 v67, v67, v75
  v_add_f32 v68, v68, v76
  v_add_f32 v69, v69, v77
  v_add_f32 v70, v70, v78
  v_add_f32 v71, v71, v79
  s_nop 1
  v_permlane16_swap_b32 v64, v68
  v_permlane16_swap_b32 v65, v69
  v_permlane16_swap_b32 v66, v70
  v_permlane16_swap_b32 v67, v71
  s_nop 1
  v_add_f32 v64, v64, v68
  v_add_f32 v65, v65, v69
  v_add_f32 v66, v66, v70
  v_add_f32 v67, v67, v71
  s_nop 1
  v_add_f32_dpp v64, v64, v64 row_ror:8 row_mask:0xf bank_mask:0xf
  v_add_f32_dpp v65, v65, v65 row_ror:8 row_mask:0xf bank_mask:0xf
  v_add_f32_dpp v66, v66, v66 row_ror:8 row_mask:0xf bank_mask:0xf
  v_add_f32_dpp v67, v67, v67 row_ror:8 row_mask:0xf bank_mask:0xf
  v_mov_b32 v68, v64
  v_mov_b32 v69, v65
  v_mov_b32 v70, v66
  v_mov_b32 v71, v67
  s_nop 1
  v_permlane32_swap_b32 v64, v68
  v_permlane32_swap_b32 v65, v69
  v_permlane32_swap_b32 v66, v70
  v_permlane32_swap_b32 v67, v71
  s_nop 1
  v_cvt_pk_bf16_f32 v64, v64, v64
  v_lshlrev_b32 v64, 16, v64
  v_cvt_pk_bf16_f32 v68, v68, v68
  v_lshlrev_b32 v68, 16, v68
  v_max_f32 v64, 0, v64
  v_mul_f32 v64, v64, v68
  v_cvt_pk_bf16_f32 v64, v64, v64
  v_lshlrev_b32 v64, 16, v64
  v_cvt_pk_bf16_f32 v65, v65, v65
  v_lshlrev_b32 v65, 16, v65
  v_cvt_pk_bf16_f32 v69, v69, v69
  v_lshlrev_b32 v69, 16, v69
  v_max_f32 v65, 0, v65
  v_mul_f32 v65, v65, v69
  v_cvt_pk_bf16_f32 v65, v65, v65
  v_lshlrev_b32 v65, 16, v65
  v_cvt_pk_bf16_f32 v66, v66, v66
  v_lshlrev_b32 v66, 16, v66
  v_cvt_pk_bf16_f32 v70, v70, v70
  v_lshlrev_b32 v70, 16, v70
  v_max_f32 v66, 0, v66
  v_mul_f32 v66, v66, v70
  v_cvt_pk_bf16_f32 v66, v66, v66
  v_lshlrev_b32 v66, 16, v66
  v_cvt_pk_bf16_f32 v67, v67, v67
  v_lshlrev_b32 v67, 16, v67
  v_cvt_pk_bf16_f32 v71, v71, v71
  v_lshlrev_b32 v71, 16, v71
  v_max_f32 v67, 0, v67
  v_mul_f32 v67, v67, v71
  v_cvt_pk_bf16_f32 v67, v67, v67
  v_lshlrev_b32 v67, 16, v67
  v_and_b32 v22, 7, v1
  v_lshlrev_b32 v22, 5, v22
  v_bfe_u32 v23, v1, 4, 1
  v_lshl_add_u32 v22, v23, 4, v22
  s_mov_b32 s68, -1
  s_mov_b32 s69, 0
  s_mov_b64 exec, s[68:69]
  ds_write_b128 v22, v[64:67] offset:1664
  s_mov_b64 exec, -1
  s_mul_i32 s49, s58, 57344
  s_add_u32 s36, s20, s49
  s_addc_u32 s37, s21, 0
  s_mov_b32 s38, 57344
  s_mov_b32 s39, 0x00020000
  v_lshlrev_b32 v22, 4, v1
  v_mov_b32 v23, 0
  v_mov_b32 v64, 0
  v_mov_b32 v65, 0
  v_mov_b32 v66, 0
  v_mov_b32 v67, 0
  v_mov_b32 v68, 0
  v_mov_b32 v69, 0
  v_mov_b32 v70, 0
  v_mov_b32 v71, 0
  s_mov_b32 s56, 0
  s_mov_b32 s57, 0
  s_waitcnt lgkmcnt(0)
L_dn:
  buffer_load_dwordx4 v[144:147], v22, s[36:39], s56 offen nt
  s_add_u32 s56, s56, 896
  buffer_load_dwordx4 v[148:151], v22, s[36:39], s56 offen nt
  s_add_u32 s56, s56, 896
  buffer_load_dwordx4 v[152:155], v22, s[36:39], s56 offen nt
  s_add_u32 s56, s56, 896
  buffer_load_dwordx4 v[156:159], v22, s[36:39], s56 offen nt
  s_add_u32 s56, s56, 896
  buffer_load_dwordx4 v[160:163], v22, s[36:39], s56 offen nt
  s_add_u32 s56, s56, 896
  buffer_load_dwordx4 v[164:167], v22, s[36:39], s56 offen nt
  s_add_u32 s56, s56, 896
  buffer_load_dwordx4 v[168:171], v22, s[36:39], s56 offen nt
  s_add_u32 s56, s56, 896
  buffer_load_dwordx4 v[172:175], v22, s[36:39], s56 offen nt
  s_add_u32 s56, s56, 896
  buffer_load_dwordx4 v[176:179], v22, s[36:39], s56 offen nt
  s_add_u32 s56, s56, 896
  buffer_load_dwordx4 v[180:183], v22, s[36:39], s56 offen nt
  s_add_u32 s56, s56, 896
  buffer_load_dwordx4 v[184:187], v22, s[36:39], s56 offen nt
  s_add_u32 s56, s56, 896
  buffer_load_dwordx4 v[188:191], v22, s[36:39], s56 offen nt
  s_add_u32 s56, s56, 896
  buffer_load_dwordx4 v[192:195], v22, s[36:39], s56 offen nt
  s_add_u32 s56, s56, 896
  buffer_load_dwordx4 v[196:199], v22, s[36:39], s56 offen nt
  s_add_u32 s56, s56, 896
  buffer_load_dwordx4 v[200:203], v22, s[36:39], s56 offen nt
  s_add_u32 s56, s56, 896
  buffer_load_dwordx4 v[204:207], v22, s[36:39], s56 offen nt
  s_add_u32 s56, s56, 896
  ds_read_b128 v[32:35], v23 offset:1664
  ds_read_b128 v[36:39], v23 offset:1680
  ds_read_b128 v[40:43], v23 offset:1696
  ds_read_b128 v[44:47], v23 offset:1712
  v_add_u32 v23, 64, v23
  s_waitcnt lgkmcnt(0)
  s_waitcnt vmcnt(15)
  v_lshrrev_b32 v24, 16, v32
  v_dot2_f32_bf16 v64, v144, v24, v64
  v_dot2_f32_bf16 v65, v144, v32, v65
  v_dot2_f32_bf16 v66, v145, v24, v66
  v_dot2_f32_bf16 v67, v145, v32, v67
  v_dot2_f32_bf16 v68, v146, v24, v68
  v_dot2_f32_bf16 v69, v146, v32, v69
  v_dot2_f32_bf16 v70, v147, v24, v70
  v_dot2_f32_bf16 v71, v147, v32, v71
  s_waitcnt vmcnt(14)
  v_lshrrev_b32 v24, 16, v33
  v_dot2_f32_bf16 v64, v148, v24, v64
  v_dot2_f32_bf16 v65, v148, v33, v65
  v_dot2_f32_bf16 v66, v149, v24, v66
  v_dot2_f32_bf16 v67, v149, v33, v67
  v_dot2_f32_bf16 v68, v150, v24, v68
  v_dot2_f32_bf16 v69, v150, v33, v69
  v_dot2_f32_bf16 v70, v151, v24, v70
  v_dot2_f32_bf16 v71, v151, v33, v71
  s_waitcnt vmcnt(13)
  v_lshrrev_b32 v24, 16, v34
  v_dot2_f32_bf16 v64, v152, v24, v64
  v_dot2_f32_bf16 v65, v152, v34, v65
  v_dot2_f32_bf16 v66, v153, v24, v66
  v_dot2_f32_bf16 v67, v153, v34, v67
  v_dot2_f32_bf16 v68, v154, v24, v68
  v_dot2_f32_bf16 v69, v154, v34, v69
  v_dot2_f32_bf16 v70, v155, v24, v70
  v_dot2_f32_bf16 v71, v155, v34, v71
  s_waitcnt vmcnt(12)
  v_lshrrev_b32 v24, 16, v35
  v_dot2_f32_bf16 v64, v156, v24, v64
  v_dot2_f32_bf16 v65, v156, v35, v65
  v_dot2_f32_bf16 v66, v157, v24, v66
  v_dot2_f32_bf16 v67, v157, v35, v67
  v_dot2_f32_bf16 v68, v158, v24, v68
  v_dot2_f32_bf16 v69, v158, v35, v69
  v_dot2_f32_bf16 v70, v159, v24, v70
  v_dot2_f32_bf16 v71, v159, v35, v71
  s_waitcnt vmcnt(11)
  v_lshrrev_b32 v24, 16, v36
  v_dot2_f32_bf16 v64, v160, v24, v64
  v_dot2_f32_bf16 v65, v160, v36, v65
  v_dot2_f32_bf16 v66, v161, v24, v66
  v_dot2_f32_bf16 v67, v161, v36, v67
  v_dot2_f32_bf16 v68, v162, v24, v68
  v_dot2_f32_bf16 v69, v162, v36, v69
  v_dot2_f32_bf16 v70, v163, v24, v70
  v_dot2_f32_bf16 v71, v163, v36, v71
  s_waitcnt vmcnt(10)
  v_lshrrev_b32 v24, 16, v37
  v_dot2_f32_bf16 v64, v164, v24, v64
  v_dot2_f32_bf16 v65, v164, v37, v65
  v_dot2_f32_bf16 v66, v165, v24, v66
  v_dot2_f32_bf16 v67, v165, v37, v67
  v_dot2_f32_bf16 v68, v166, v24, v68
  v_dot2_f32_bf16 v69, v166, v37, v69
  v_dot2_f32_bf16 v70, v167, v24, v70
  v_dot2_f32_bf16 v71, v167, v37, v71
  s_waitcnt vmcnt(9)
  v_lshrrev_b32 v24, 16, v38
  v_dot2_f32_bf16 v64, v168, v24, v64
  v_dot2_f32_bf16 v65, v168, v38, v65
  v_dot2_f32_bf16 v66, v169, v24, v66
  v_dot2_f32_bf16 v67, v169, v38, v67
  v_dot2_f32_bf16 v68, v170, v24, v68
  v_dot2_f32_bf16 v69, v170, v38, v69
  v_dot2_f32_bf16 v70, v171, v24, v70
  v_dot2_f32_bf16 v71, v171, v38, v71
  s_waitcnt vmcnt(8)
  v_lshrrev_b32 v24, 16, v39
  v_dot2_f32_bf16 v64, v172, v24, v64
  v_dot2_f32_bf16 v65, v172, v39, v65
  v_dot2_f32_bf16 v66, v173, v24, v66
  v_dot2_f32_bf16 v67, v173, v39, v67
  v_dot2_f32_bf16 v68, v174, v24, v68
  v_dot2_f32_bf16 v69, v174, v39, v69
  v_dot2_f32_bf16 v70, v175, v24, v70
  v_dot2_f32_bf16 v71, v175, v39, v71
  s_waitcnt vmcnt(7)
  v_lshrrev_b32 v24, 16, v40
  v_dot2_f32_bf16 v64, v176, v24, v64
  v_dot2_f32_bf16 v65, v176, v40, v65
  v_dot2_f32_bf16 v66, v177, v24, v66
  v_dot2_f32_bf16 v67, v177, v40, v67
  v_dot2_f32_bf16 v68, v178, v24, v68
  v_dot2_f32_bf16 v69, v178, v40, v69
  v_dot2_f32_bf16 v70, v179, v24, v70
  v_dot2_f32_bf16 v71, v179, v40, v71
  s_waitcnt vmcnt(6)
  v_lshrrev_b32 v24, 16, v41
  v_dot2_f32_bf16 v64, v180, v24, v64
  v_dot2_f32_bf16 v65, v180, v41, v65
  v_dot2_f32_bf16 v66, v181, v24, v66
  v_dot2_f32_bf16 v67, v181, v41, v67
  v_dot2_f32_bf16 v68, v182, v24, v68
  v_dot2_f32_bf16 v69, v182, v41, v69
  v_dot2_f32_bf16 v70, v183, v24, v70
  v_dot2_f32_bf16 v71, v183, v41, v71
  s_waitcnt vmcnt(5)
  v_lshrrev_b32 v24, 16, v42
  v_dot2_f32_bf16 v64, v184, v24, v64
  v_dot2_f32_bf16 v65, v184, v42, v65
  v_dot2_f32_bf16 v66, v185, v24, v66
  v_dot2_f32_bf16 v67, v185, v42, v67
  v_dot2_f32_bf16 v68, v186, v24, v68
  v_dot2_f32_bf16 v69, v186, v42, v69
  v_dot2_f32_bf16 v70, v187, v24, v70
  v_dot2_f32_bf16 v71, v187, v42, v71
  s_waitcnt vmcnt(4)
  v_lshrrev_b32 v24, 16, v43
  v_dot2_f32_bf16 v64, v188, v24, v64
  v_dot2_f32_bf16 v65, v188, v43, v65
  v_dot2_f32_bf16 v66, v189, v24, v66
  v_dot2_f32_bf16 v67, v189, v43, v67
  v_dot2_f32_bf16 v68, v190, v24, v68
  v_dot2_f32_bf16 v69, v190, v43, v69
  v_dot2_f32_bf16 v70, v191, v24, v70
  v_dot2_f32_bf16 v71, v191, v43, v71
  s_waitcnt vmcnt(3)
  v_lshrrev_b32 v24, 16, v44
  v_dot2_f32_bf16 v64, v192, v24, v64
  v_dot2_f32_bf16 v65, v192, v44, v65
  v_dot2_f32_bf16 v66, v193, v24, v66
  v_dot2_f32_bf16 v67, v193, v44, v67
  v_dot2_f32_bf16 v68, v194, v24, v68
  v_dot2_f32_bf16 v69, v194, v44, v69
  v_dot2_f32_bf16 v70, v195, v24, v70
  v_dot2_f32_bf16 v71, v195, v44, v71
  s_waitcnt vmcnt(2)
  v_lshrrev_b32 v24, 16, v45
  v_dot2_f32_bf16 v64, v196, v24, v64
  v_dot2_f32_bf16 v65, v196, v45, v65
  v_dot2_f32_bf16 v66, v197, v24, v66
  v_dot2_f32_bf16 v67, v197, v45, v67
  v_dot2_f32_bf16 v68, v198, v24, v68
  v_dot2_f32_bf16 v69, v198, v45, v69
  v_dot2_f32_bf16 v70, v199, v24, v70
  v_dot2_f32_bf16 v71, v199, v45, v71
  s_waitcnt vmcnt(1)
  v_lshrrev_b32 v24, 16, v46
  v_dot2_f32_bf16 v64, v200, v24, v64
  v_dot2_f32_bf16 v65, v200, v46, v65
  v_dot2_f32_bf16 v66, v201, v24, v66
  v_dot2_f32_bf16 v67, v201, v46, v67
  v_dot2_f32_bf16 v68, v202, v24, v68
  v_dot2_f32_bf16 v69, v202, v46, v69
  v_dot2_f32_bf16 v70, v203, v24, v70
  v_dot2_f32_bf16 v71, v203, v46, v71
  s_waitcnt vmcnt(0)
  v_lshrrev_b32 v24, 16, v47
  v_dot2_f32_bf16 v64, v204, v24, v64
  v_dot2_f32_bf16 v65, v204, v47, v65
  v_dot2_f32_bf16 v66, v205, v24, v66
  v_dot2_f32_bf16 v67, v205, v47, v67
  v_dot2_f32_bf16 v68, v206, v24, v68
  v_dot2_f32_bf16 v69, v206, v47, v69
  v_dot2_f32_bf16 v70, v207, v24, v70
  v_dot2_f32_bf16 v71, v207, v47, v71
  s_add_u32 s57, s57, 1
  s_cmp_lt_u32 s57, 4
  s_cbranch_scc1 L_dn
  v_mov_b32 v144, v64
  v_mov_b32 v145, v65
  v_mov_b32 v146, v66
  v_mov_b32 v147, s47
  v_mov_b32 v148, v67
  v_mov_b32 v149, v68
  v_mov_b32 v150, v69
  v_mov_b32 v151, s47
  v_mov_b32 v152, v70
  v_mov_b32 v153, v71
  v_mov_b32 v154, 0
  v_mov_b32 v155, s47
  s_mul_i32 s49, s58, 2688
  s_add_u32 s49, s49, 4194304
  s_add_u32 s36, s26, s49
  s_addc_u32 s37, s27, 0
  s_mov_b32 s38, 2688
  s_mov_b32 s39, 0x00020000
  v_lshlrev_b32 v22, 4, v1
  s_mov_b32 s68, -1
  s_mov_b32 s69, 0x00ffffff
  s_mov_b64 exec, s[68:69]
  buffer_store_dwordx4 v[144:147], v22, s[36:39], 0 offen offset:0 sc1
  buffer_store_dwordx4 v[148:151], v22, s[36:39], 0 offen offset:896 sc1
  buffer_store_dwordx4 v[152:155], v22, s[36:39], 0 offen offset:1792 sc1
  s_mov_b64 exec, -1
L_nomlp:
  s_cmp_lt_u32 s67, 21
  s_cbranch_scc0 L_feed
  s_lshl_b32 s49, s67, 7
  s_add_u32 s49, s49, 4194304
  s_add_u32 s36, s26, s49
  s_addc_u32 s37, s27, 0
  s_mov_b32 s38, 75264
  s_mov_b32 s39, 0x00020000
  v_lshrrev_b32 v22, 3, v1
  v_and_b32 v23, 7, v1
  v_lshlrev_b32 v23, 4, v23
  v_add_u32 v26, 0, v22
  v_min_u32 v26, 27, v26
  v_mul_u32_u24 v26, 2688, v26
  v_add_u32 v160, v26, v23
  v_add_u32 v26, 8, v22
  v_min_u32 v26, 27, v26
  v_mul_u32_u24 v26, 2688, v26
  v_add_u32 v161, v26, v23
  v_add_u32 v26, 16, v22
  v_min_u32 v26, 27, v26
  v_mul_u32_u24 v26, 2688, v26
  v_add_u32 v162, v26, v23
  v_add_u32 v26, 24, v22
  v_min_u32 v26, 27, v26
  v_mul_u32_u24 v26, 2688, v26
  v_add_u32 v163, v26, v23
  s_mov_b32 s66, 0
L_pfb_3:
  buffer_load_dwordx4 v[144:147], v160, s[36:39], 0 offen sc1
  buffer_load_dwordx4 v[148:151], v161, s[36:39], 0 offen sc1
  buffer_load_dwordx4 v[152:155], v162, s[36:39], 0 offen sc1
  buffer_load_dwordx4 v[156:159], v163, s[36:39], 0 offen sc1
  s_waitcnt vmcnt(0)
  v_xor_b32 v24, s47, v147
  v_xor_b32 v25, s47, v151
  v_or_b32 v24, v24, v25
  v_xor_b32 v25, s47, v155
  v_or_b32 v24, v24, v25
  v_xor_b32 v25, s47, v159
  v_or_b32 v24, v24, v25
  v_cmp_ne_u32 vcc, 0, v24
  s_nop 4
  s_cbranch_vccz L_pfbok_4
  s_add_u32 s66, s66, 1
  s_cmp_lt_u32 s66, 65536
  s_sleep 16
  s_cbranch_scc1 L_pfb_3
L_pfbok_4:
  v_cmp_gt_u32 vcc, 4, v22
  s_nop 1
  v_cndmask_b32 v64, 0, v156, vcc
  v_add_f32 v64, v64, v144
  v_add_f32 v24, v148, v152
  v_add_f32 v64, v64, v24
  v_cndmask_b32 v65, 0, v157, vcc
  v_add_f32 v65, v65, v145
  v_add_f32 v24, v149, v153
  v_add_f32 v65, v65, v24
  v_cndmask_b32 v66, 0, v158, vcc
  v_add_f32 v66, v66, v146
  v_add_f32 v24, v150, v154
  v_add_f32 v66, v66, v24
  s_nop 1
  v_add_f32_dpp v64, v64, v64 row_ror:8 row_mask:0xf bank_mask:0xf
  v_add_f32_dpp v65, v65, v65 row_ror:8 row_mask:0xf bank_mask:0xf
  v_add_f32_dpp v66, v66, v66 row_ror:8 row_mask:0xf bank_mask:0xf
  v_mov_b32 v24, v64
  s_nop 1
  v_permlane16_swap_b32 v64, v24
  s_nop 1
  v_add_f32 v64, v64, v24
  v_mov_b32 v24, v64
  s_nop 1
  v_permlane32_swap_b32 v64, v24
  s_nop 1
  v_add_f32 v64, v64, v24
  v_mov_b32 v24, v65
  s_nop 1
  v_permlane16_swap_b32 v65, v24
  s_nop 1
  v_add_f32 v65, v65, v24
  v_mov_b32 v24, v65
  s_nop 1
  v_permlane32_swap_b32 v65, v24
  s_nop 1
  v_add_f32 v65, v65, v24
  v_mov_b32 v24, v66
  s_nop 1
  v_permlane16_swap_b32 v66, v24
  s_nop 1
  v_add_f32 v66, v66, v24
  v_mov_b32 v24, v66
  s_nop 1
  v_permlane32_swap_b32 v66, v24
  s_nop 1
  v_add_f32 v66, v66, v24
  v_mov_b32 v67, 0
  ds_write_b128 v23, v[64:67] offset:1920
  s_waitcnt lgkmcnt(0)
L_feed:
  s_lshr_b32 s49, s2, 3
  s_lshl_b32 s49, s49, 8
  s_add_u32 s49, s49, 32768
  s_add_u32 s96, s26, s49
  s_addc_u32 s97, s27, 0
  s_mov_b32 s98, 8
  s_mov_b32 s99, 0x00020000
  v_mov_b32 v29, 0
  v_mov_b32 v22, 1024
  s_mov_b32 s56, s92
  s_mov_b32 s66, 0
L_feedloop:
  ds_read_b32 v23, v22
  s_waitcnt lgkmcnt(0)
  v_readfirstlane_b32 s57, v23
  s_add_u32 s57, s57, 3
  s_sub_i32 s57, s57, s56
  s_cmp_gt_i32 s57, 0
  s_cbranch_scc1 L_feedgo
  s_sleep 4
  s_add_u32 s66, s66, 1
  s_cmp_lt_u32 s66, 1048576
  s_cbranch_scc1 L_feedloop
  s_branch L_feedend
L_feedgo:
  s_min_u32 s57, s57, 8
L_feedretry:
  s_mov_b64 exec, 1
  v_mov_b32 v30, s57
  v_mov_b32 v31, 0
  buffer_atomic_add_x2 v[30:31], v29, s[96:99], 0 offen sc0
  s_mov_b64 exec, -1
  s_waitcnt vmcnt(0)
  v_readfirstlane_b32 s50, v31
  v_readfirstlane_b32 s49, v30
  s_cmp_eq_u32 s50, s47
  s_cbranch_scc1 L_feedok
  s_add_u32 s66, s66, 1
  s_cmp_lt_u32 s66, 1048576
  s_cbranch_scc1 L_feedretry
  s_mov_b32 s49, 1024
L_feedok:
  s_add_u32 s51, s49, s57
  s_cmp_ge_u32 s51, 1024
  s_cselect_b32 s57, 32, s57
  v_add_u32 v24, s49, v1
  v_add_u32 v25, s56, v1
  v_lshlrev_b32 v25, 2, v25
  s_lshl_b64 s[68:69], 1, s57
  s_sub_u32 s68, s68, 1
  s_subb_u32 s69, s69, 0
  s_mov_b64 exec, s[68:69]
  ds_write_b32 v25, v24 offset:12288
  s_mov_b64 exec, -1
  s_add_u32 s56, s56, s57
  s_cmp_lt_u32 s51, 1024
  s_cbranch_scc1 L_feedloop
L_feedend:
  s_waitcnt lgkmcnt(0)
L_combine:
  v_mov_b32 v22, v21
  s_nop 1
  v_permlane16_swap_b32 v21, v22
  s_nop 1
  v_add_f32 v21, v21, v22
  v_mov_b32 v22, v21
  s_nop 1
  v_permlane32_swap_b32 v21, v22
  s_nop 1
  v_add_f32 v21, v21, v22
  v_bfe_u32 v22, v1, 3, 1
  v_lshlrev_b32 v23, 3, v22
  s_lshl_b32 s49, s46, 4
  v_add_u32 v23, s49, v23
  ds_write_b64 v23, v[20:21] offset:1040
  v_lshlrev_b32 v25, 10, v22
  v_lshrrev_b32 v26, 4, v1
  v_lshl_add_u32 v25, v26, 7, v25
  v_and_b32 v26, 7, v1
  v_lshl_add_u32 v25, v26, 2, v25
  s_lshl_b32 s49, s46, 11
  v_add_u32 v25, s49, v25
  ds_write_b32 v25, v12 offset:4096
  ds_write_b32 v25, v13 offset:4128
  ds_write_b32 v25, v14 offset:4160
  ds_write_b32 v25, v15 offset:4192
  ds_write_b32 v25, v16 offset:4608
  ds_write_b32 v25, v17 offset:4640
  ds_write_b32 v25, v18 offset:4672
  ds_write_b32 v25, v19 offset:4704
  s_lshl_b32 s49, s44, 5
  s_add_u32 s49, s49, s45
  s_lshl_b32 s49, s49, 13
  s_add_u32 s49, s49, 2097152
  s_add_u32 s36, s26, s49
  s_addc_u32 s37, s27, 0
  s_mov_b32 s38, 8192
  s_mov_b32 s39, 0x00020000
  s_mov_b32 s50, 4096
  s_waitcnt lgkmcnt(0)
  s_barrier
  v_mov_b32 v23, 0
  ds_read_b128 v[68:71], v23 offset:1056
  ds_read_b128 v[72:75], v23 offset:1072
  ds_read_b128 v[76:79], v23 offset:1088
  v_lshlrev_b32 v22, 2, v0
  ds_read_b32 v40, v22 offset:6144
  ds_read_b32 v41, v22 offset:8192
  ds_read_b32 v42, v22 offset:10240
  ds_read_b32 v43, v22 offset:7168
  ds_read_b32 v44, v22 offset:9216
  ds_read_b32 v45, v22 offset:11264
  v_lshlrev_b32 v22, 4, v0
  s_waitcnt lgkmcnt(6)
  v_max3_f32 v13, v68, v72, v76
  v_sub_f32 v32, v68, v13
  v_sub_f32 v33, v72, v13
  v_sub_f32 v34, v76, v13
  v_exp_f32 v32, v32
  v_exp_f32 v33, v33
  v_exp_f32 v34, v34
  s_nop 0
  v_mul_f32 v14, v32, v69
  v_fmac_f32 v14, v33, v73
  v_fmac_f32 v14, v34, v77
  v_mov_b32 v15, s47
  v_max3_f32 v17, v70, v74, v78
  v_sub_f32 v35, v70, v17
  v_sub_f32 v36, v74, v17
  v_sub_f32 v37, v78, v17
  v_exp_f32 v35, v35
  v_exp_f32 v36, v36
  v_exp_f32 v37, v37
  s_nop 0
  v_mul_f32 v18, v35, v71
  v_fmac_f32 v18, v36, v75
  v_fmac_f32 v18, v37, v79
  v_mov_b32 v19, s47
  s_waitcnt lgkmcnt(0)
  v_mul_f32 v12, v32, v40
  v_fmac_f32 v12, v33, v41
  v_fmac_f32 v12, v34, v42
  v_mul_f32 v16, v35, v43
  v_fmac_f32 v16, v36, v44
  v_fmac_f32 v16, v37, v45
  buffer_store_dwordx4 v[12:15], v22, s[36:39], 0 offen sc1
  buffer_store_dwordx4 v[16:19], v22, s[36:39], s50 offen sc1
  s_cmp_eq_u32 s46, 0
  s_cbranch_scc0 L_s1done
  s_lshl_b32 s49, s44, 18
  s_lshl_b32 s50, s45, 8
  s_add_u32 s49, s49, s50
  s_add_u32 s49, s49, 2097152
  s_add_u32 s36, s26, s49
  s_addc_u32 s37, s27, 0
  s_mov_b32 s38, 262144
  s_mov_b32 s39, 0x00020000
  v_lshrrev_b32 v22, 4, v1
  v_lshlrev_b32 v22, 13, v22
  v_and_b32 v23, 15, v1
  v_lshl_add_u32 v22, v23, 4, v22
  v_add_u32 v192, 0, v22
  v_add_u32 v193, 32768, v22
  v_add_u32 v194, 65536, v22
  v_add_u32 v195, 98304, v22
  v_add_u32 v196, 131072, v22
  v_add_u32 v197, 163840, v22
  v_add_u32 v198, 196608, v22
  v_add_u32 v199, 229376, v22
  s_mov_b32 s66, 0
  s_mov_b32 s64, 255
L_pp_5:
  s_bitcmp1_b32 s64, 0
  s_cbranch_scc0 L_pps_7
  buffer_load_dwordx4 v[160:163], v192, s[36:39], 0 offen sc1
L_pps_7:
  s_bitcmp1_b32 s64, 1
  s_cbranch_scc0 L_pps_8
  buffer_load_dwordx4 v[164:167], v193, s[36:39], 0 offen sc1
L_pps_8:
  s_bitcmp1_b32 s64, 2
  s_cbranch_scc0 L_pps_9
  buffer_load_dwordx4 v[168:171], v194, s[36:39], 0 offen sc1
L_pps_9:
  s_bitcmp1_b32 s64, 3
  s_cbranch_scc0 L_pps_10
  buffer_load_dwordx4 v[172:175], v195, s[36:39], 0 offen sc1
L_pps_10:
  s_bitcmp1_b32 s64, 4
  s_cbranch_scc0 L_pps_11
  buffer_load_dwordx4 v[176:179], v196, s[36:39], 0 offen sc1
L_pps_11:
  s_bitcmp1_b32 s64, 5
  s_cbranch_scc0 L_pps_12
  buffer_load_dwordx4 v[180:183], v197, s[36:39], 0 offen sc1
L_pps_12:
  s_bitcmp1_b32 s64, 6
  s_cbranch_scc0 L_pps_13
  buffer_load_dwordx4 v[184:187], v198, s[36:39], 0 offen sc1
L_pps_13:
  s_bitcmp1_b32 s64, 7
  s_cbranch_scc0 L_pps_14
  buffer_load_dwordx4 v[188:191], v199, s[36:39], 0 offen sc1
L_pps_14:
  s_waitcnt vmcnt(0)
  v_cmp_ne_u32 vcc, s47, v163
  s_nop 0
  s_cmp_eq_u64 vcc, 0
  s_cselect_b32 s65, 0xfffffffe, -1
  s_and_b32 s64, s64, s65
  v_cmp_ne_u32 vcc, s47, v167
  s_nop 0
  s_cmp_eq_u64 vcc, 0
  s_cselect_b32 s65, 0xfffffffd, -1
  s_and_b32 s64, s64, s65
  v_cmp_ne_u32 vcc, s47, v171
  s_nop 0
  s_cmp_eq_u64 vcc, 0
  s_cselect_b32 s65, 0xfffffffb, -1
  s_and_b32 s64, s64, s65
  v_cmp_ne_u32 vcc, s47, v175
  s_nop 0
  s_cmp_eq_u64 vcc, 0
  s_cselect_b32 s65, 0xfffffff7, -1
  s_and_b32 s64, s64, s65
  v_cmp_ne_u32 vcc, s47, v179
  s_nop 0
  s_cmp_eq_u64 vcc, 0
  s_cselect_b32 s65, 0xffffffef, -1
  s_and_b32 s64, s64, s65
  v_cmp_ne_u32 vcc, s47, v183
  s_nop 0
  s_cmp_eq_u64 vcc, 0
  s_cselect_b32 s65, 0xffffffdf, -1
  s_and_b32 s64, s64, s65
  v_cmp_ne_u32 vcc, s47, v187
  s_nop 0
  s_cmp_eq_u64 vcc, 0
  s_cselect_b32 s65, 0xffffffbf, -1
  s_and_b32 s64, s64, s65
  v_cmp_ne_u32 vcc, s47, v191
  s_nop 0
  s_cmp_eq_u64 vcc, 0
  s_cselect_b32 s65, 0xffffff7f, -1
  s_and_b32 s64, s64, s65
  s_cmp_eq_u32 s64, 0
  s_cbranch_scc1 L_ppok_6
  s_add_u32 s66, s66, 1
  s_cmp_lt_u32 s66, 65536
  s_sleep 1
  s_cbranch_scc1 L_pp_5
L_ppok_6:
  v_max3_f32 v23, v161, v165, v169
  v_max3_f32 v23, v23, v173, v177
  v_max3_f32 v23, v23, v181, v185
  v_max_f32 v23, v23, v189
  v_mov_b32 v24, v23
  s_nop 1
  v_permlane16_swap_b32 v23, v24
  s_nop 1
  v_max_f32 v23, v23, v24
  v_mov_b32 v24, v23
  s_nop 1
  v_permlane32_swap_b32 v23, v24
  s_nop 1
  v_max_f32 v23, v23, v24
  v_sub_f32 v161, v161, v23
  v_sub_f32 v165, v165, v23
  v_sub_f32 v169, v169, v23
  v_sub_f32 v173, v173, v23
  v_sub_f32 v177, v177, v23
  v_sub_f32 v181, v181, v23
  v_sub_f32 v185, v185, v23
  v_sub_f32 v189, v189, v23
  v_exp_f32 v161, v161
  v_exp_f32 v165, v165
  v_exp_f32 v169, v169
  v_exp_f32 v173, v173
  v_exp_f32 v177, v177
  v_exp_f32 v181, v181
  v_exp_f32 v185, v185
  v_exp_f32 v189, v189
  s_nop 0
  v_mul_f32 v25, v161, v160
  v_mul_f32 v26, v161, v162
  v_fmac_f32 v25, v165, v164
  v_fmac_f32 v26, v165, v166
  v_fmac_f32 v25, v169, v168
  v_fmac_f32 v26, v169, v170
  v_fmac_f32 v25, v173, v172
  v_fmac_f32 v26, v173, v174
  v_fmac_f32 v25, v177, v176
  v_fmac_f32 v26, v177, v178
  v_fmac_f32 v25, v181, v180
  v_fmac_f32 v26, v181, v182
  v_fmac_f32 v25, v185, v184
  v_fmac_f32 v26, v185, v186
  v_fmac_f32 v25, v189, v188
  v_fmac_f32 v26, v189, v190
  v_mov_b32 v24, v25
  s_nop 1
  v_permlane16_swap_b32 v25, v24
  s_nop 1
  v_add_f32 v25, v25, v24
  v_mov_b32 v24, v25
  s_nop 1
  v_permlane32_swap_b32 v25, v24
  s_nop 1
  v_add_f32 v25, v25, v24
  v_mov_b32 v24, v26
  s_nop 1
  v_permlane16_swap_b32 v26, v24
  s_nop 1
  v_add_f32 v26, v26, v24
  v_mov_b32 v24, v26
  s_nop 1
  v_permlane32_swap_b32 v26, v24
  s_nop 1
  v_add_f32 v26, v26, v24
  v_rcp_f32 v27, v26
  s_nop 0
  v_mul_f32 v28, v25, v27
  v_fma_f32 v25, -v28, v26, v25
  v_fma_f32 v25, v25, v27, v28
  s_nop 1
  v_mov_b32_dpp v26, v25 row_shl:1 row_mask:0xf bank_mask:0xf
  s_nop 0
  v_cvt_pk_bf16_f32 v25, v25, v26
  s_nop 0
  v_readlane_b32 s56, v25, 0
  v_readlane_b32 s57, v25, 2
  v_readlane_b32 s58, v25, 4
  v_readlane_b32 s59, v25, 6
  v_readlane_b32 s60, v25, 8
  v_readlane_b32 s61, v25, 10
  v_readlane_b32 s62, v25, 12
  v_readlane_b32 s63, v25, 14
  s_nop 1
  v_dot2_f32_bf16 v64, v80, s56, 0
  v_dot2_f32_bf16 v65, v81, s56, 0
  v_dot2_f32_bf16 v66, v82, s56, 0
  v_dot2_f32_bf16 v67, v83, s56, 0
  v_dot2_f32_bf16 v68, v84, s56, 0
  v_dot2_f32_bf16 v69, v85, s56, 0
  v_dot2_f32_bf16 v70, v86, s56, 0
  v_dot2_f32_bf16 v71, v87, s56, 0
  v_dot2_f32_bf16 v64, v88, s57, v64
  v_dot2_f32_bf16 v65, v89, s57, v65
  v_dot2_f32_bf16 v66, v90, s57, v66
  v_dot2_f32_bf16 v67, v91, s57, v67
  v_dot2_f32_bf16 v68, v92, s57, v68
  v_dot2_f32_bf16 v69, v93, s57, v69
  v_dot2_f32_bf16 v70, v94, s57, v70
  v_dot2_f32_bf16 v71, v95, s57, v71
  v_dot2_f32_bf16 v64, v96, s58, v64
  v_dot2_f32_bf16 v65, v97, s58, v65
  v_dot2_f32_bf16 v66, v98, s58, v66
  v_dot2_f32_bf16 v67, v99, s58, v67
  v_dot2_f32_bf16 v68, v100, s58, v68
  v_dot2_f32_bf16 v69, v101, s58, v69
  v_dot2_f32_bf16 v70, v102, s58, v70
  v_dot2_f32_bf16 v71, v103, s58, v71
  v_dot2_f32_bf16 v64, v104, s59, v64
  v_dot2_f32_bf16 v65, v105, s59, v65
  v_dot2_f32_bf16 v66, v106, s59, v66
  v_dot2_f32_bf16 v67, v107, s59, v67
  v_dot2_f32_bf16 v68, v108, s59, v68
  v_dot2_f32_bf16 v69, v109, s59, v69
  v_dot2_f32_bf16 v70, v110, s59, v70
  v_dot2_f32_bf16 v71, v111, s59, v71
  v_dot2_f32_bf16 v64, v112, s60, v64
  v_dot2_f32_bf16 v65, v113, s60, v65
  v_dot2_f32_bf16 v66, v114, s60, v66
  v_dot2_f32_bf16 v67, v115, s60, v67
  v_dot2_f32_bf16 v68, v116, s60, v68
  v_dot2_f32_bf16 v69, v117, s60, v69
  v_dot2_f32_bf16 v70, v118, s60, v70
  v_dot2_f32_bf16 v71, v119, s60, v71
  v_dot2_f32_bf16 v64, v120, s61, v64
  v_dot2_f32_bf16 v65, v121, s61, v65
  v_dot2_f32_bf16 v66, v122, s61, v66
  v_dot2_f32_bf16 v67, v123, s61, v67
  v_dot2_f32_bf16 v68, v124, s61, v68
  v_dot2_f32_bf16 v69, v125, s61, v69
  v_dot2_f32_bf16 v70, v126, s61, v70
  v_dot2_f32_bf16 v71, v127, s61, v71
  v_dot2_f32_bf16 v64, v128, s62, v64
  v_dot2_f32_bf16 v65, v129, s62, v65
  v_dot2_f32_bf16 v66, v130, s62, v66
  v_dot2_f32_bf16 v67, v131, s62, v67
  v_dot2_f32_bf16 v68, v132, s62, v68
  v_dot2_f32_bf16 v69, v133, s62, v69
  v_dot2_f32_bf16 v70, v134, s62, v70
  v_dot2_f32_bf16 v71, v135, s62, v71
  v_dot2_f32_bf16 v64, v136, s63, v64
  v_dot2_f32_bf16 v65, v137, s63, v65
  v_dot2_f32_bf16 v66, v138, s63, v66
  v_dot2_f32_bf16 v67, v139, s63, v67
  v_dot2_f32_bf16 v68, v140, s63, v68
  v_dot2_f32_bf16 v69, v141, s63, v69
  v_dot2_f32_bf16 v70, v142, s63, v70
  v_dot2_f32_bf16 v71, v143, s63, v71
  v_mov_b32 v144, v64
  v_mov_b32 v145, v65
  v_mov_b32 v146, v66
  v_mov_b32 v147, s47
  v_mov_b32 v148, v67
  v_mov_b32 v149, v68
  v_mov_b32 v150, v69
  v_mov_b32 v151, s47
  v_mov_b32 v152, v70
  v_mov_b32 v153, v71
  v_mov_b32 v154, 0
  v_mov_b32 v155, s47
  s_mul_i32 s49, s2, 2688
  s_add_u32 s49, s49, 262144
  s_add_u32 s36, s26, s49
  s_addc_u32 s37, s27, 0
  s_mov_b32 s38, 2688
  s_mov_b32 s39, 0x00020000
  v_lshlrev_b32 v22, 4, v1
  s_mov_b32 s68, -1
  s_mov_b32 s69, 0x00ffffff
  s_mov_b64 exec, s[68:69]
  buffer_store_dwordx4 v[144:147], v22, s[36:39], 0 offen offset:0 sc1
  buffer_store_dwordx4 v[148:151], v22, s[36:39], 0 offen offset:896 sc1
  buffer_store_dwordx4 v[152:155], v22, s[36:39], 0 offen offset:1792 sc1
  s_mov_b64 exec, -1
L_s1done:
  s_cmp_lt_u32 s67, 21
  s_cbranch_scc0 L_fin
  s_barrier
  s_lshl_b32 s49, s67, 7
  s_add_u32 s49, s49, 262144
  s_add_u32 s36, s26, s49
  s_addc_u32 s37, s27, 0
  s_mov_b32 s38, 688128
  s_mov_b32 s39, 0x00020000
  v_lshrrev_b32 v22, 3, v0
  v_and_b32 v23, 7, v22
  v_lshrrev_b32 v22, 3, v22
  v_lshl_add_u32 v22, v22, 6, v23
  v_mul_u32_u24 v22, 2688, v22
  v_and_b32 v23, 7, v1
  v_lshlrev_b32 v23, 4, v23
  v_add_u32 v22, v22, v23
  v_add_u32 v144, 0, v22
  v_add_u32 v145, 21504, v22
  v_add_u32 v146, 43008, v22
  v_add_u32 v147, 64512, v22
  v_add_u32 v148, 86016, v22
  v_add_u32 v149, 107520, v22
  v_add_u32 v150, 129024, v22
  v_add_u32 v151, 150528, v22
  s_mul_i32 s52, s67, 37
  s_lshr_b32 s52, s52, 8
  s_mul_i32 s53, s52, 7
  s_sub_u32 s53, s67, s53
  s_lshl_b32 s53, s53, 6
  s_mul_i32 s54, s52, 3
  s_add_u32 s53, s53, s54
  v_and_b32 v26, 7, v1
  v_lshlrev_b32 v26, 3, v26
  v_lshrrev_b32 v27, 3, v1
  v_add_u32 v26, v26, v27
  v_add_u32 v26, s53, v26
  v_lshlrev_b32 v26, 1, v26
  v_add_u32 v28, s54, v27
  v_cmp_gt_u32 vcc, 8, v28
  v_cmp_gt_u32 s[68:69], 3, v27
  s_nop 1
  s_and_b64 s[68:69], s[68:69], vcc
  s_mov_b32 s40, s4
  s_mov_b32 s41, s5
  s_mov_b32 s42, 896
  s_mov_b32 s43, 0x00020000
  buffer_load_ushort v72, v26, s[40:43], 0 offen
  s_mov_b32 s66, 0
  s_mov_b32 s64, 255
L_pfa_15:
  s_bitcmp1_b32 s64, 0
  s_cbranch_scc0 L_pfas_17
  buffer_load_dwordx4 v[32:35], v144, s[36:39], 0 offen sc1
L_pfas_17:
  s_bitcmp1_b32 s64, 1
  s_cbranch_scc0 L_pfas_18
  buffer_load_dwordx4 v[36:39], v145, s[36:39], 0 offen sc1
L_pfas_18:
  s_bitcmp1_b32 s64, 2
  s_cbranch_scc0 L_pfas_19
  buffer_load_dwordx4 v[40:43], v146, s[36:39], 0 offen sc1
L_pfas_19:
  s_bitcmp1_b32 s64, 3
  s_cbranch_scc0 L_pfas_20
  buffer_load_dwordx4 v[44:47], v147, s[36:39], 0 offen sc1
L_pfas_20:
  s_bitcmp1_b32 s64, 4
  s_cbranch_scc0 L_pfas_21
  buffer_load_dwordx4 v[48:51], v148, s[36:39], 0 offen sc1
L_pfas_21:
  s_bitcmp1_b32 s64, 5
  s_cbranch_scc0 L_pfas_22
  buffer_load_dwordx4 v[52:55], v149, s[36:39], 0 offen sc1
L_pfas_22:
  s_bitcmp1_b32 s64, 6
  s_cbranch_scc0 L_pfas_23
  buffer_load_dwordx4 v[56:59], v150, s[36:39], 0 offen sc1
L_pfas_23:
  s_bitcmp1_b32 s64, 7
  s_cbranch_scc0 L_pfas_24
  buffer_load_dwordx4 v[60:63], v151, s[36:39], 0 offen sc1
L_pfas_24:
  s_waitcnt vmcnt(0)
  v_cmp_ne_u32 vcc, s47, v35
  s_nop 0
  s_cmp_eq_u64 vcc, 0
  s_cselect_b32 s65, 0xfffffffe, -1
  s_and_b32 s64, s64, s65
  v_cmp_ne_u32 vcc, s47, v39
  s_nop 0
  s_cmp_eq_u64 vcc, 0
  s_cselect_b32 s65, 0xfffffffd, -1
  s_and_b32 s64, s64, s65
  v_cmp_ne_u32 vcc, s47, v43
  s_nop 0
  s_cmp_eq_u64 vcc, 0
  s_cselect_b32 s65, 0xfffffffb, -1
  s_and_b32 s64, s64, s65
  v_cmp_ne_u32 vcc, s47, v47
  s_nop 0
  s_cmp_eq_u64 vcc, 0
  s_cselect_b32 s65, 0xfffffff7, -1
  s_and_b32 s64, s64, s65
  v_cmp_ne_u32 vcc, s47, v51
  s_nop 0
  s_cmp_eq_u64 vcc, 0
  s_cselect_b32 s65, 0xffffffef, -1
  s_and_b32 s64, s64, s65
  v_cmp_ne_u32 vcc, s47, v55
  s_nop 0
  s_cmp_eq_u64 vcc, 0
  s_cselect_b32 s65, 0xffffffdf, -1
  s_and_b32 s64, s64, s65
  v_cmp_ne_u32 vcc, s47, v59
  s_nop 0
  s_cmp_eq_u64 vcc, 0
  s_cselect_b32 s65, 0xffffffbf, -1
  s_and_b32 s64, s64, s65
  v_cmp_ne_u32 vcc, s47, v63
  s_nop 0
  s_cmp_eq_u64 vcc, 0
  s_cselect_b32 s65, 0xffffff7f, -1
  s_and_b32 s64, s64, s65
  s_cmp_eq_u32 s64, 0
  s_cbranch_scc1 L_pfaok_16
  s_add_u32 s66, s66, 1
  s_cmp_lt_u32 s66, 65536
  s_sleep 1
  s_cbranch_scc1 L_pfa_15
L_pfaok_16:
  v_add_f32 v64, v32, v36
  v_add_f32 v24, v40, v44
  v_add_f32 v64, v64, v24
  v_add_f32 v24, v48, v52
  v_add_f32 v25, v56, v60
  v_add_f32 v24, v24, v25
  v_add_f32 v64, v64, v24
  v_add_f32 v65, v33, v37
  v_add_f32 v24, v41, v45
  v_add_f32 v65, v65, v24
  v_add_f32 v24, v49, v53
  v_add_f32 v25, v57, v61
  v_add_f32 v24, v24, v25
  v_add_f32 v65, v65, v24
  v_add_f32 v66, v34, v38
  v_add_f32 v24, v42, v46
  v_add_f32 v66, v66, v24
  v_add_f32 v24, v50, v54
  v_add_f32 v25, v58, v62
  v_add_f32 v24, v24, v25
  v_add_f32 v66, v66, v24
  s_nop 1
  v_add_f32_dpp v64, v64, v64 row_ror:8 row_mask:0xf bank_mask:0xf
  v_add_f32_dpp v65, v65, v65 row_ror:8 row_mask:0xf bank_mask:0xf
  v_add_f32_dpp v66, v66, v66 row_ror:8 row_mask:0xf bank_mask:0xf
  v_mov_b32 v24, v64
  s_nop 1
  v_permlane16_swap_b32 v64, v24
  s_nop 1
  v_add_f32 v64, v64, v24
  v_mov_b32 v24, v64
  s_nop 1
  v_permlane32_swap_b32 v64, v24
  s_nop 1
  v_add_f32 v64, v64, v24
  v_mov_b32 v24, v65
  s_nop 1
  v_permlane16_swap_b32 v65, v24
  s_nop 1
  v_add_f32 v65, v65, v24
  v_mov_b32 v24, v65
  s_nop 1
  v_permlane32_swap_b32 v65, v24
  s_nop 1
  v_add_f32 v65, v65, v24
  v_mov_b32 v24, v66
  s_nop 1
  v_permlane16_swap_b32 v66, v24
  s_nop 1
  v_add_f32 v66, v66, v24
  v_mov_b32 v24, v66
  s_nop 1
  v_permlane32_swap_b32 v66, v24
  s_nop 1
  v_add_f32 v66, v66, v24
  v_mov_b32 v67, 0
  s_lshl_b32 s49, s46, 7
  v_add_u32 v24, s49, v23
  ds_write_b128 v24, v[64:67] offset:1152
  s_mov_b32 s40, s22
  s_mov_b32 s41, s23
  s_mov_b32 s42, 896
  s_mov_b32 s43, 0x00020000
  s_waitcnt lgkmcnt(0)
  s_barrier
  s_cmp_eq_u32 s46, 0
  s_cbranch_scc0 L_fin
  v_min_u32 v27, 3, v27
  v_lshl_add_u32 v23, v27, 2, v23
  ds_read_b32 v64, v23 offset:1152
  ds_read_b32 v65, v23 offset:1280
  ds_read_b32 v66, v23 offset:1408
  ds_read_b32 v67, v23 offset:1536
  ds_read_b32 v68, v23 offset:1920
  s_waitcnt vmcnt(0) lgkmcnt(0)
  v_add_f32 v64, v64, v65
  v_add_f32 v66, v66, v67
  v_add_f32 v64, v64, v66
  v_cvt_pk_bf16_f32 v64, v64, v64
  v_lshlrev_b32 v64, 16, v64
  v_cvt_pk_bf16_f32 v68, v68, v68
  v_lshlrev_b32 v68, 16, v68
  v_lshlrev_b32 v72, 16, v72
  v_add_f32 v64, v72, v64
  v_cvt_pk_bf16_f32 v64, v64, v64
  v_lshlrev_b32 v64, 16, v64
  v_add_f32 v64, v64, v68
  v_cvt_pk_bf16_f32 v64, v64, v64
  s_mov_b64 exec, s[68:69]
  buffer_store_short v64, v26, s[40:43], 0 offen
  s_mov_b64 exec, -1
  s_cmp_eq_u32 s67, 0
  s_cbranch_scc0 L_fin
  s_mov_b32 s36, s26
  s_mov_b32 s37, s27
  s_mov_b32 s38, 4
  s_mov_b32 s39, 0x00020000
  v_mov_b32 v22, 0
  v_mov_b32 v23, s47
  s_mov_b64 exec, 1
  buffer_store_dword v23, v22, s[36:39], 0 offen
  s_mov_b64 exec, -1
L_fin:
L_end:
  s_endpgm
.section .rodata,"a"
.p2align 6
.amdhsa_kernel parallel_sum__gqa_block_cached__glu_gated_reglu__decode_kernel
  .amdhsa_next_free_vgpr 512
  .amdhsa_next_free_sgpr 102
  .amdhsa_accum_offset 256
  .amdhsa_group_segment_fixed_size 0
  .amdhsa_kernarg_size 96
  .amdhsa_user_sgpr_count 2
  .amdhsa_user_sgpr_kernarg_segment_ptr 1
  .amdhsa_system_sgpr_workgroup_id_x 1
.end_amdhsa_kernel
```
